```python
import torch

def _softmax(x, axis=-1):
    return torch.softmax(x, dim=axis)
def _gelu(x):
    return torch.nn.functional.gelu(x, approximate="tanh")
def _silu(x):
    return torch.nn.functional.silu(x)
def _sigmoid(x):
    return torch.sigmoid(x)
def _layernorm(x, axis=-1, eps=1e-5):
    m = x.mean(dim=axis, keepdim=True)
    v = x.var(dim=axis, keepdim=True, unbiased=False)
    return (x - m) / torch.sqrt(v + eps)
def _scatter_add(tgt, idx, src, axis=0):
    return tgt.clone().index_add_(axis, idx, src)
def _segment_sum(src, seg, n):
    out = torch.zeros((n,) + src.shape[1:], dtype=src.dtype)
    return out.index_add_(0, seg, src)
def _pad(x, pw):
    flat = tuple(v for pair in reversed(pw) for v in pair)
    return torch.nn.functional.pad(x, flat)

kernel_name = 'recurrent_scan__ssm_conv_h3__swiglu_ffn__prompt'

def setup_inputs():

    _w = (lambda a: (lambda t: t.to(torch.bfloat16) if t.is_floating_point() else t)(torch.as_tensor(a)))
    def _A_setup():
        B, S, D = 1, 2048, 512
        ks = 4
        return {
            "q": _w((lambda *s: torch.randn(*s, dtype=torch.bfloat16) * 0.05)(B, S, D)),
            "k": _w((lambda *s: torch.randn(*s, dtype=torch.bfloat16) * 0.2)(B, S, D)),
            "v": _w((lambda *s: torch.randn(*s, dtype=torch.bfloat16) * 0.2)(B, S, D)),
            "shift_k": _w((lambda *s: torch.randn(*s, dtype=torch.bfloat16) * 0.2)(D, ks) * 0.5),
            "ssm_k": _w((lambda *s: torch.randn(*s, dtype=torch.bfloat16) * 0.2)(D, S) * (1.0 / S ** 0.5)),
            "ssm_D": _w((lambda *s: torch.randn(*s, dtype=torch.bfloat16) * 0.2)(D)),
        }
    _A_in = _A_setup()

    def _B_setup():
        B, S, D, F = 1, 2048, 512, 1792
        return {
            "x": _w((lambda *s: torch.randn(*s, dtype=torch.bfloat16) * 0.05)(B, S, D)),
            "w_gate": _w((lambda *s: torch.randn(*s, dtype=torch.bfloat16) * 0.1)(D, F)),
            "w_up": _w((lambda *s: torch.randn(*s, dtype=torch.bfloat16) * 0.1)(D, F)),
            "w_down": _w((lambda *s: torch.randn(*s, dtype=torch.bfloat16) * 0.1)(F, D)),
        }
    _B_in = _B_setup()

    return {
        "A_q": _A_in["q"],
        "A_k": _A_in["k"],
        "A_v": _A_in["v"],
        "A_shift_k": _A_in["shift_k"],
        "A_ssm_k": _A_in["ssm_k"],
        "A_ssm_D": _A_in["ssm_D"],
        "B_x": _B_in["x"],
        "B_w_gate": _B_in["w_gate"],
        "B_w_up": _B_in["w_up"],
        "B_w_down": _B_in["w_down"],
    }

def reference(A_q, A_k, A_v, A_shift_k, A_ssm_k, A_ssm_D, B_x, B_w_gate, B_w_up, B_w_down):
    def _A_ref(q, k, v, shift_k, ssm_k, ssm_D):
        B, S, D = q.shape
        ks = shift_k.shape[-1]
        k_pad = _pad(k, ((0, 0), (ks - 1, 0), (0, 0)))
        k_shift = torch.zeros_like(k)
        for t in range(ks):
            k_shift = k_shift + k_pad[:, t:t + S, :] * shift_k[:, ks - 1 - t][None, None, :]
        kv = k_shift * v
        L = 2 * S
        kv_pad = _pad(kv, ((0, 0), (0, S), (0, 0)))
        kf_pad = _pad(ssm_k, ((0, 0), (0, S)))
        kv_f = (lambda x, axes=(-2,-1): torch.fft.rfft2(x.float(), dim=axes))(kv_pad[:, None, :, :], axes=(1, 2))
        kf_f = (lambda x, axes=(-2,-1): torch.fft.rfft2(x.float(), dim=axes))(kf_pad[:, None, :], axes=(1, 2))
        kf_f = (lambda x, *d: x.permute(*d))(kf_f, 1, 2, 0)
        y_f = kv_f * kf_f[None, :, :, :]
        y = (lambda x, s, axes=(-2,-1): torch.fft.irfft2(x, s=s, dim=axes).to(torch.bfloat16))(y_f, (1, L), axes=(1, 2))[:, 0, :S, :]
        y = y + kv * ssm_D[None, None, :]
        return q * y

    def _B_ref(x, w_gate, w_up, w_down):
        g = _silu(x @ w_gate)
        u = x @ w_up
        return (g * u) @ w_down

    x = A_q
    xn = _layernorm(x, axis=-1)
    s = _A_ref(xn, A_k, A_v, A_shift_k, A_ssm_k, A_ssm_D)
    g = _silu(_B_ref(xn, B_w_gate, B_w_up, B_w_down))
    return x + s * g
```

```asm
; @launch grid=(256,1,1) block=(256,1,1) lds=163840
.amdgcn_target "amdgcn-amd-amdhsa--gfx950"
.text
.globl recurrent_scan__ssm_conv_h3__swiglu_ffn__prompt_kernel
.p2align 8
.type recurrent_scan__ssm_conv_h3__swiglu_ffn__prompt_kernel,@function
recurrent_scan__ssm_conv_h3__swiglu_ffn__prompt_kernel:
    s_cmp_ge_u32 s2, 256
    s_cbranch_scc1 L_end
    s_load_dwordx16 s[8:23], s[0:1], 0
    s_load_dwordx8 s[24:31], s[0:1], 64
    s_load_dwordx2 s[32:33], s[0:1], 96
    v_lshrrev_b32 v2, 6, v0
    v_and_b32 v1, 63, v0
    s_and_b32 s4, s2, 7
    v_readfirstlane_b32 s3, v2
    s_lshr_b32 s5, s2, 3
    v_lshrrev_b32 v3, 4, v1
    v_and_b32 v4, 15, v1
    v_lshrrev_b32 v5, 3, v1
    v_and_b32 v6, 7, v1
    v_lshrrev_b32 v7, 2, v4
    v_and_b32 v8, 3, v1
    v_lshlrev_b32 v122, 4, v1
    v_mov_b32 v16, 0
    s_lshr_b32 s7, s4, 1
    s_and_b32 s74, s4, 1
    s_and_b32 s75, s5, 3
    s_lshr_b32 s72, s5, 2
    s_lshl_b32 s69, s7, 2
    s_add_u32 s69, s69, s75
    s_mul_i32 s68, s74, 7
    s_add_u32 s68, s68, s72
    s_lshl_b32 s84, s2, 3
    s_lshl_b32 s7, s4, 8
    s_lshl_b32 s74, s5, 3
    s_add_u32 s7, s7, s74
    s_lshl_b32 s74, s3, 1
    s_add_u32 s84, s7, s74
    s_lshl_b32 s77, s84, 10
    s_add_u32 s70, s75, s72
    s_and_b32 s70, s70, 3
    s_and_b32 s74, s4, 4
    s_and_b32 s70, s70, 1
    s_and_b32 s74, s4, 6
    s_add_u32 s70, s70, s74
    s_waitcnt lgkmcnt(0)
    s_mov_b32 s36, s8
    s_mov_b32 s37, s9
    s_mov_b32 s38, 2097152
    s_mov_b32 s39, 0x20000
    buffer_load_dwordx4 v[20:23], v122, s[36:39], s77 offen
    buffer_load_dwordx4 v[24:27], v122, s[36:39], s77 offen offset:1024
    s_add_u32 s64, s32, 134217728
    s_addc_u32 s65, s33, 0
    s_mov_b32 s66, 16777216
    s_mov_b32 s67, 0x20000
    buffer_load_dword v17, v16, s[64:67], 0 offen sc1
    s_cmp_ge_u32 s5, 28
    s_cbranch_scc1 L_srole
    s_lshl_b32 s80, s3, 12
    s_add_u32 s80, s80, 32768
    s_lshl_b32 s7, s69, 17
    s_lshl_b32 s74, s3, 15
    s_add_u32 s7, s7, s74
    v_xor_b32 v92, v6, v3
    v_lshlrev_b32_e64 v92, 4, v92
    v_lshl_add_u32 v92, v5, 10, v92
    v_add_u32 v84, s7, v92
    v_xor_b32 v93, 64, v84
    v_add_u32 v85, 7168, v93
    v_add_u32 v86, 14336, v84
    v_add_u32 v87, 21504, v93
    s_xor_b32 s76, s70, 0
    s_mov_b32 m0, s80
    s_lshl_b32 s83, s76, 7
    s_nop 0
    buffer_load_dwordx4 v84, s[36:39], s83 offen offset:0  lds
    buffer_load_dwordx4 v85, s[36:39], s83 offen offset:1024  lds
    buffer_load_dwordx4 v86, s[36:39], s83 offen offset:2048  lds
    buffer_load_dwordx4 v87, s[36:39], s83 offen offset:3072  lds
    s_and_b32 s7, s3, 1
    s_cmp_eq_u32 s7, 0
    s_cselect_b32 s48, s22, s24
    s_cselect_b32 s49, s23, s25
    s_mov_b32 s50, 1835008
    s_mov_b32 s51, 0x20000
    v_lshrrev_b32 v92, 1, v4
    v_xor_b32 v92, v92, v3
    s_lshl_b32 s74, s7, 2
    v_xor_b32 v92, s74, v92
    v_lshlrev_b32 v92, 5, v92
    v_and_b32 v93, 1, v1
    v_lshl_add_u32 v92, v93, 4, v92
    v_mul_u32_u24 v93, 3584, v3
    v_add_u32 v92, v92, v93
    s_lshr_b32 s74, s3, 1
    s_mul_i32 s75, s74, 57344
    s_lshl_b32 s77, s68, 8
    s_add_u32 s75, s75, s77
    v_add_u32_e64 v88, s75, v92
    v_add_u32 v89, 13312, v88
    v_add_u32 v90, 26624, v88
    v_add_u32 v91, 39936, v88
    s_lshl_b32 s79, s7, 14
    s_lshl_b32 s74, s74, 12
    s_add_u32 s79, s79, s74
    s_bfe_u32 s7, s5, 0x10001
    s_mul_i32 s40, s7, 114688
    s_lshl_b32 s41, s40, 1
    s_sub_u32 s41, 114688, s41
    s_mov_b32 m0, s79
    s_mul_i32 s82, s76, 229376
    s_add_u32 s82, s82, s40
    buffer_load_dwordx4 v88, s[48:51], s82 offen offset:0  lds
    buffer_load_dwordx4 v89, s[48:51], s82 offen offset:1024  lds
    buffer_load_dwordx4 v90, s[48:51], s82 offen offset:2048  lds
    buffer_load_dwordx4 v91, s[48:51], s82 offen offset:3072  lds
    s_getpc_b64 s[34:35]
L_pcg:
    s_sub_u32 s34, s34, L_pcg-recurrent_scan__ssm_conv_h3__swiglu_ffn__prompt_kernel
    s_subb_u32 s35, s35, 0
    s_lshl_b32 s7, s5, 2
    s_add_u32 s7, s7, s3
    s_mul_i32 s7, s7, 384
    v_min_u32_e64 v18, 2, v1
    v_lshl_add_u32 v18, v18, 7, s7
    v_min_u32 v18, L_codeend-recurrent_scan__ssm_conv_h3__swiglu_ffn__prompt_kernel-4, v18
    global_load_dword v18, v18, s[34:35]
    s_lshl_b32 s73, s4, 6
    s_lshl_b32 s7, s5, 1
    s_add_u32 s73, s73, s7
    s_lshr_b32 s7, s3, 1
    s_add_u32 s73, s73, s7
    s_lshl_b32 s74, s73, 12
    s_load_dwordx2 s[100:101], s[16:17], s74
    s_lshr_b32 s7, s73, 1
    s_lshl_b32 s7, s7, 2
    s_load_dword s85, s[18:19], s7
    v_and_b32 v92, 1, v3
    v_lshrrev_b32 v93, 1, v3
    v_lshl_add_u32 v93, v93, 3, v7
    v_lshlrev_b32_e64 v93, 8, v93
    v_lshl_add_u32 v93, v92, 14, v93
    v_lshl_add_u32 v93, v8, 3, v93
    v_lshlrev_b32 v92, 2, v92
    v_xor_b32 v92, v92, v7
    v_lshl_add_u32 v104, v92, 5, v93
    s_and_b32 s7, s3, 2
    s_lshl_b32 s7, s7, 6
    v_xor_b32 v96, s7, v104
    v_xor_b32 v97, 32, v96
    v_xor_b32_e64 v98, 64, v96
    v_xor_b32 v99, 96, v96
    v_add_u32 v100, 98304, v96
    v_add_u32 v101, 98304, v97
    v_add_u32 v102, 98304, v98
    v_add_u32 v103, 98304, v99
    v_and_b32 v92, 31, v1
    v_lshrrev_b32 v93, 1, v92
    v_and_b32 v93, 7, v93
    v_lshrrev_b32 v94, 5, v1
    v_xor_b32 v93, v93, v94
    v_lshlrev_b32 v93, 4, v93
    v_lshl_add_u32 v93, v92, 7, v93
    s_and_b32 s7, s5, 2
    s_lshl_b32 s7, s7, 5
    v_xor_b32 v93, s7, v93
    s_and_b32 s7, s3, 1
    s_lshl_b32 s7, s7, 13
    s_add_u32 s7, s7, 32768
    v_add_u32 v112, s7, v93
    v_xor_b32 v113, 32, v112
    v_xor_b32 v114, 64, v112
    v_xor_b32 v115, 96, v112
    v_add_u32 v116, 98304, v112
    v_add_u32 v117, 98304, v113
    v_add_u32 v118, 98304, v114
    v_add_u32 v119, 98304, v115
    v_accvgpr_write_b32 a162, 0
    v_accvgpr_write_b32 a163, 0
    v_accvgpr_write_b32 a166, 0
    v_accvgpr_write_b32 a167, 0
    v_accvgpr_write_b32 a170, 0
    v_accvgpr_write_b32 a171, 0
    v_accvgpr_write_b32 a174, 0
    v_accvgpr_write_b32 a175, 0
    s_lshl_b32 s7, s3, 6
    v_xor_b32 v105, s7, v104
    v_xor_b32 v106, 32, v105
    s_lshl_b32 s74, s68, 4
    s_lshl_b32 s75, s70, 1
    s_add_u32 s74, s74, s75
    s_bfe_u32 s75, s5, 0x10001
    s_add_u32 s74, s74, s75
    s_lshl_b32 s74, s74, 10
    s_lshl_b32 s7, s3, 8
    s_add_u32 s74, s74, s7
    s_add_u32 s74, s74, 294912
    v_lshl_add_u32 v107, v1, 2, s74
    s_mov_b32 s56, s26
    s_mov_b32 s57, s27
    s_mov_b32 s58, 1835008
    s_mov_b32 s59, 0x20000
    v_lshrrev_b32 v92, 1, v4
    v_xor_b32 v92, v92, v3
    v_lshlrev_b32 v92, 5, v92
    v_and_b32 v93, 1, v1
    v_lshl_add_u32 v92, v93, 4, v92
    v_lshl_add_u32 v92, v3, 10, v92
    s_mul_i32 s94, s4, 7
    s_add_u32 s94, s94, s72
    s_lshl_b32 s7, s94, 15
    s_lshl_b32 s74, s3, 13
    s_add_u32 s7, s7, s74
    s_and_b32 s74, s5, 3
    s_lshl_b32 s74, s74, 8
    s_add_u32 s7, s7, s74
    v_add_u32_e64 v72, s7, v92
    v_xor_b32 v73, 128, v72
    v_add_u32 v73, 3072, v73
    s_lshl_b32 s7, s3, 11
    s_add_u32 s12, s7, 147456
    s_mov_b32 s52, s16
    s_mov_b32 s53, s17
    s_mov_b32 s54, 2097152
    s_mov_b32 s55, 0x20000
    s_mov_b32 s60, s28
    s_mov_b32 s61, s29
    s_mov_b32 s62, 2097152
    s_mov_b32 s63, 0x20000
    s_lshl_b32 s71, s4, 2
    s_and_b32 s74, s5, 3
    s_add_u32 s71, s71, s74
    s_lshr_b32 s7, s3, 1
    s_mul_i32 s10, s7, 21760
    s_add_u32 s10, s10, 98304
    s_lshl_b32 s74, s73, 12
    s_and_b32 s75, s3, 1
    s_lshl_b32 s75, s75, 11
    s_add_u32 s31, s75, s74
    s_mul_i32 s74, s73, 4224
    s_add_u32 s96, s75, s74
    s_lshl_b32 s95, s4, 12
    s_lshl_b32 s74, s5, 7
    s_add_u32 s95, s95, s74
    s_add_u32 s95, s95, 32768
    v_mov_b32 v12, 0x3f803f80
    s_waitcnt vmcnt(11)
    v_dot2_f32_bf16 v28, v20, v12, 0
    v_dot2_f32_bf16 v30, v20, v20, 0
    s_waitcnt vmcnt(10)
    s_nop 0
    v_dot2_f32_bf16 v29, v24, v12, 0
    v_dot2_f32_bf16 v31, v24, v24, 0
    v_dot2_f32_bf16 v28, v21, v12, v28
    v_dot2_f32_bf16 v30, v21, v21, v30
    v_dot2_f32_bf16 v29, v25, v12, v29
    v_dot2_f32_bf16 v31, v25, v25, v31
    v_dot2_f32_bf16 v28, v22, v12, v28
    v_dot2_f32_bf16 v30, v22, v22, v30
    v_dot2_f32_bf16 v29, v26, v12, v29
    v_dot2_f32_bf16 v31, v26, v26, v31
    v_dot2_f32_bf16 v28, v23, v12, v28
    v_dot2_f32_bf16 v30, v23, v23, v30
    v_dot2_f32_bf16 v29, v27, v12, v29
    v_dot2_f32_bf16 v31, v27, v27, v31
    s_waitcnt vmcnt(9)
    v_readfirstlane_b32 s6, v17
    v_lshrrev_b32 v13, 5, v1
    v_add_u32 v13, s84, v13
    v_permlane32_swap_b32 v28, v29
    v_permlane32_swap_b32 v30, v31
    s_add_u32 s6, s6, 1
    s_cmp_eq_u32 s3, 0
    s_cselect_b32 s20, 0, 0x80000000
    s_cselect_b32 s21, s6, 0
    v_add_f32 v28, v28, v29
    v_add_f32 v30, v30, v31
    v_lshlrev_b32 v13, 3, v13
    v_mov_b32 v29, v28
    v_mov_b32 v31, v30
    v_add_u32 v13, 262144, v13
    v_and_b32 v14, 31, v1
    v_permlane16_swap_b32 v28, v29
    v_permlane16_swap_b32 v30, v31
    v_cmp_eq_u32 vcc, 0, v14
    v_add_f32 v28, v28, v29
    v_add_f32 v30, v30, v31
    v_mov_b32 v14, 0x80000000
    v_cndmask_b32_e64 v13, v14, v13, vcc
    v_add_f32_dpp v28, v28, v28 row_ror:8 row_mask:0xf bank_mask:0xf
    v_add_f32_dpp v30, v30, v30 row_ror:8 row_mask:0xf bank_mask:0xf
    s_nop 0
    v_add_f32_dpp v28, v28, v28 row_ror:4 row_mask:0xf bank_mask:0xf
    v_add_f32_dpp v30, v30, v30 row_ror:4 row_mask:0xf bank_mask:0xf
    s_nop 0
    v_add_f32_dpp v28, v28, v28 row_ror:2 row_mask:0xf bank_mask:0xf
    v_add_f32_dpp v30, v30, v30 row_ror:2 row_mask:0xf bank_mask:0xf
    s_nop 0
    s_nop 0
    v_add_f32_dpp v28, v28, v28 row_ror:1 row_mask:0xf bank_mask:0xf
    v_add_f32_dpp v30, v30, v30 row_ror:1 row_mask:0xf bank_mask:0xf
    v_mul_f32 v28, 0x3b000000, v28
    v_mul_f32 v30, 0x3b000000, v30
    v_fma_f32 v29, -v28, v28, v30
    v_max_f32_e64 v29, 0, v29
    v_add_f32 v29, 0x3727c5ac, v29
    buffer_store_dwordx2 v[28:29], v13, s[64:67], 0 offen sc1
    s_add_u32 m0, s79, 8192
    s_add_u32 s82, s82, s41
    s_nop 0
    buffer_load_dwordx4 v88, s[48:51], s82 offen offset:0  lds
    buffer_load_dwordx4 v89, s[48:51], s82 offen offset:1024  lds
    buffer_load_dwordx4 v90, s[48:51], s82 offen offset:2048  lds
    buffer_load_dwordx4 v91, s[48:51], s82 offen offset:3072  lds
    s_mov_b32 m0, s12
    s_nop 0
    buffer_load_dwordx4 v72, s[56:59], 0 offen lds
    buffer_load_dwordx4 v73, s[56:59], 0 offen offset:1024 lds
    s_xor_b32 s76, s70, 1
    s_add_u32 m0, s80, 49152
    s_lshl_b32 s83, s76, 7
    buffer_load_dwordx4 v84, s[36:39], s83 offen offset:0  lds
    buffer_load_dwordx4 v85, s[36:39], s83 offen offset:1024  lds
    v_lshrrev_b32 v92, 1, v3
    v_lshlrev_b32 v92, 4, v92
    v_and_b32_e64 v93, 1, v3
    v_lshl_add_u32 v93, v93, 2, v7
    v_add_u32 v92, v92, v93
    v_lshlrev_b32 v92, 8, v92
    v_lshl_add_u32 v92, v8, 3, v92
    s_lshl_b32 s7, s3, 1
    v_xor_b32 v93, s7, v93
    v_lshl_add_u32 v92, v93, 5, v92
    v_add_u32 v74, 147456, v92
    v_xor_b32 v75, 32, v74
    s_and_b32 s7, s5, 3
    s_lshl_b32 s7, s7, 1
    s_lshr_b32 s74, s3, 1
    s_add_u32 s7, s7, s74
    s_mul_i32 s7, s7, 56
    s_add_u32 s94, s94, s7
    s_lshl_b32 s94, s94, 12
    s_and_b32 s7, s3, 1
    s_lshl_b32 s7, s7, 11
    s_add_u32 s94, s94, s7
    s_add_u32 s94, s94, 14155776
    s_and_b32 s75, s3, 1
    s_lshl_b32 s74, s75, 11
    s_add_u32 s74, s74, s10
    v_add_u32_e64 v92, s74, v122
    v_mul_u32_u24 v93, 4160, v3
    v_lshl_add_u32 v93, v4, 1, v93
    v_add_u32 v93, s10, v93
    v_add_u32 v94, s10, v122
    v_add_u32 v123, v4, v3
    v_subrev_u32 v123, 16, v123
    v_lshlrev_b32 v124, 4, v123
    s_waitcnt lgkmcnt(0)
    v_lshrrev_b64 v[66:67], v124, s[100:101]
    v_cmp_gt_i32 vcc, 0, v123
    s_nop 1
    v_cndmask_b32 v66, v66, 0, vcc
    v_add_u32 v123, 1, v4
    v_and_b32 v124, 3, v123
    v_mul_u32_u24 v124, 4160, v124
    s_waitcnt vmcnt(10)
    s_barrier
    ds_read_b64_tr_b16 v[32:33], v105 offset:0
    ds_read_b64_tr_b16 v[34:35], v105 offset:1024
    ds_read_b64_tr_b16 v[36:37], v105 offset:4096
    ds_read_b64_tr_b16 v[38:39], v105 offset:5120
    ds_read_b64_tr_b16 v[40:41], v106 offset:0
    ds_read_b64_tr_b16 v[42:43], v106 offset:1024
    ds_read_b64_tr_b16 v[44:45], v106 offset:4096
    ds_read_b64_tr_b16 v[46:47], v106 offset:5120
    ds_read_b128 a[232:235], v112 offset:0
    ds_read_b64_tr_b16 a[204:205], v96 offset:0
    ds_read_b64_tr_b16 a[206:207], v96 offset:1024
    ds_read_b128 a[236:239], v112 offset:4096
    ds_read_b64_tr_b16 a[208:209], v97 offset:0
    ds_read_b64_tr_b16 a[210:211], v97 offset:1024
    ds_read_b64_tr_b16 a[212:213], v98 offset:0
    s_waitcnt lgkmcnt(14)
    v_dot2_f32_bf16 v48, v32, v12, 0
    s_waitcnt lgkmcnt(10)
    v_dot2_f32_bf16 v49, v40, v12, 0
    v_dot2_f32_bf16 v48, v33, v12, v48
    v_dot2_f32_bf16 v49, v41, v12, v49
    v_dot2_f32_bf16 v48, v34, v12, v48
    s_waitcnt lgkmcnt(9)
    s_nop 0
    v_dot2_f32_bf16 v49, v42, v12, v49
    v_dot2_f32_bf16 v48, v35, v12, v48
    v_dot2_f32_bf16 v49, v43, v12, v49
    v_dot2_f32_bf16 v48, v36, v12, v48
    s_waitcnt lgkmcnt(8)
    s_nop 0
    v_dot2_f32_bf16 v49, v44, v12, v49
    v_dot2_f32_bf16 v48, v37, v12, v48
    v_dot2_f32_bf16 v49, v45, v12, v49
    v_dot2_f32_bf16 v48, v38, v12, v48
    s_waitcnt lgkmcnt(7)
    v_dot2_f32_bf16 v49, v46, v12, v49
    v_dot2_f32_bf16 v48, v39, v12, v48
    v_dot2_f32_bf16 v49, v47, v12, v49
    s_nop 2
    v_permlane32_swap_b32 v48, v49
    v_add_f32 v48, v48, v49
    buffer_store_dword v48, v107, s[64:67], 0 offen sc1
    s_waitcnt lgkmcnt(3)
    s_nop 0
    v_mfma_f32_32x32x16_bf16 v[128:143], a[204:207], a[232:235], 0
    ds_read_b64_tr_b16 a[214:215], v98 offset:1024
    buffer_load_dwordx4 v86, s[36:39], s83 offen offset:2048  lds
    v_mfma_f32_32x32x16_bf16 v[192:207], a[204:207], a[236:239], 0
    ds_read_b64_tr_b16 a[216:217], v99 offset:0
    ds_read_b64_tr_b16 a[218:219], v99 offset:1024
    ds_read_b128 a[240:243], v113 offset:0
    s_waitcnt lgkmcnt(3)
    s_nop 0
    v_mfma_f32_32x32x16_bf16 v[144:159], a[208:211], a[232:235], 0
    buffer_load_dwordx4 v87, s[36:39], s83 offen offset:3072  lds
    v_mfma_f32_32x32x16_bf16 v[208:223], a[208:211], a[236:239], 0
    ds_read_b64_tr_b16 a[220:221], v96 offset:4096
    ds_read_b64_tr_b16 a[222:223], v96 offset:5120
    ds_read_b128 a[244:247], v113 offset:4096
    v_mfma_f32_32x32x16_bf16 v[160:175], a[212:215], a[232:235], 0
    s_add_u32 m0, s79, 49152
    s_mul_i32 s82, s76, 229376
    s_add_u32 s82, s82, s40
    v_mfma_f32_32x32x16_bf16 v[224:239], a[212:215], a[236:239], 0
    buffer_load_dwordx4 v88, s[48:51], s82 offen offset:0  lds
    ds_read_b64_tr_b16 a[224:225], v97 offset:4096
    s_waitcnt lgkmcnt(5)
    v_mfma_f32_32x32x16_bf16 v[176:191], a[216:219], a[232:235], 0
    ds_read_b64_tr_b16 a[226:227], v97 offset:5120
    buffer_load_dwordx4 v89, s[48:51], s82 offen offset:1024  lds
    v_mfma_f32_32x32x16_bf16 v[240:255], a[216:219], a[236:239], 0
    ds_read_b64_tr_b16 a[228:229], v98 offset:4096
    ds_read_b64_tr_b16 a[230:231], v98 offset:5120
    ds_read_b64_tr_b16 a[204:205], v99 offset:4096
    s_waitcnt lgkmcnt(5)
    s_nop 0
    v_mfma_f32_32x32x16_bf16 v[128:143], a[220:223], a[240:243], v[128:143]
    buffer_load_dwordx4 v90, s[48:51], s82 offen offset:2048  lds
    v_mfma_f32_32x32x16_bf16 v[192:207], a[220:223], a[244:247], v[192:207]
    ds_read_b64_tr_b16 a[206:207], v99 offset:5120
    s_waitcnt lgkmcnt(4)
    v_mfma_f32_32x32x16_bf16 v[144:159], a[224:227], a[240:243], v[144:159]
    buffer_load_dwordx4 v91, s[48:51], s82 offen offset:3072  lds
    v_mfma_f32_32x32x16_bf16 v[208:223], a[224:227], a[244:247], v[208:223]
    s_waitcnt vmcnt(11)
    s_barrier
    ds_read_b128 a[248:251], v114 offset:0
    ds_read_b64_tr_b16 a[208:209], v96 offset:8192
    ds_read_b64_tr_b16 a[210:211], v96 offset:9216
    s_waitcnt lgkmcnt(3)
    v_mfma_f32_32x32x16_bf16 v[160:175], a[228:231], a[240:243], v[160:175]
    ds_read_b128 a[252:255], v114 offset:4096
    s_add_u32 m0, s79, 57344
    s_add_u32 s82, s82, s41
    s_nop 0
    v_mfma_f32_32x32x16_bf16 v[224:239], a[228:231], a[244:247], v[224:239]
    buffer_load_dwordx4 v88, s[48:51], s82 offen offset:0  lds
    ds_read_b64_tr_b16 a[212:213], v97 offset:8192
    ds_read_b64_tr_b16 a[214:215], v97 offset:9216
    v_mfma_f32_32x32x16_bf16 v[176:191], a[204:207], a[240:243], v[176:191]
    ds_read_b64_tr_b16 a[216:217], v98 offset:8192
    buffer_load_dwordx4 v89, s[48:51], s82 offen offset:1024  lds
    v_mfma_f32_32x32x16_bf16 v[240:255], a[204:207], a[244:247], v[240:255]
    ds_read_b64_tr_b16 a[218:219], v98 offset:9216
    s_waitcnt lgkmcnt(4)
    s_nop 0
    v_mfma_f32_32x32x16_bf16 v[128:143], a[208:211], a[248:251], v[128:143]
    ds_read_b64_tr_b16 a[220:221], v99 offset:8192
    ds_read_b64_tr_b16 a[222:223], v99 offset:9216
    v_mfma_f32_32x32x16_bf16 v[192:207], a[208:211], a[252:255], v[192:207]
    buffer_load_dwordx4 v90, s[48:51], s82 offen offset:2048  lds
    ds_read_b128 a[232:235], v115 offset:0
    s_waitcnt lgkmcnt(3)
    s_nop 0
    v_mfma_f32_32x32x16_bf16 v[144:159], a[212:215], a[248:251], v[144:159]
    ds_read_b64_tr_b16 a[224:225], v96 offset:12288
    buffer_load_dwordx4 v91, s[48:51], s82 offen offset:3072  lds
    v_mfma_f32_32x32x16_bf16 v[208:223], a[212:215], a[252:255], v[208:223]
    ds_read_b64_tr_b16 a[226:227], v96 offset:13312
    ds_read_b128 a[236:239], v115 offset:4096
    ds_read_b64_tr_b16 a[228:229], v97 offset:12288
    v_mfma_f32_32x32x16_bf16 v[160:175], a[216:219], a[248:251], v[160:175]
    s_xor_b32 s76, s70, 2
    s_add_u32 m0, s80, 98304
    s_lshl_b32 s83, s76, 7
    v_mfma_f32_32x32x16_bf16 v[224:239], a[216:219], a[252:255], v[224:239]
    buffer_load_dwordx4 v84, s[36:39], s83 offen offset:0  lds
    s_waitcnt lgkmcnt(5)
    s_nop 0
    v_mfma_f32_32x32x16_bf16 v[176:191], a[220:223], a[248:251], v[176:191]
    ds_read_b64_tr_b16 a[230:231], v97 offset:13312
    ds_read_b64_tr_b16 a[204:205], v98 offset:12288
    ds_read_b64_tr_b16 a[206:207], v98 offset:13312
    v_mfma_f32_32x32x16_bf16 v[240:255], a[220:223], a[252:255], v[240:255]
    buffer_load_dwordx4 v85, s[36:39], s83 offen offset:1024  lds
    s_waitcnt lgkmcnt(4)
    s_nop 0
    v_mfma_f32_32x32x16_bf16 v[128:143], a[224:227], a[232:235], v[128:143]
    ds_read_b64_tr_b16 a[208:209], v99 offset:12288
    ds_read_b64_tr_b16 a[210:211], v99 offset:13312
    v_mfma_f32_32x32x16_bf16 v[192:207], a[224:227], a[236:239], v[192:207]
    buffer_load_dwordx4 v86, s[36:39], s83 offen offset:2048  lds
    s_waitcnt lgkmcnt(4)
    v_mfma_f32_32x32x16_bf16 v[144:159], a[228:231], a[232:235], v[144:159]
    buffer_load_dwordx4 v87, s[36:39], s83 offen offset:3072  lds
    v_mfma_f32_32x32x16_bf16 v[208:223], a[228:231], a[236:239], v[208:223]
    s_waitcnt vmcnt(4) lgkmcnt(0)
    s_barrier
    s_nop 0
    ds_read_b128 a[240:243], v112 offset:49152
    ds_read_b64_tr_b16 a[212:213], v96 offset:49152
    v_mfma_f32_32x32x16_bf16 v[160:175], a[204:207], a[232:235], v[160:175]
    ds_read_b64_tr_b16 a[214:215], v96 offset:50176
    s_add_u32 m0, s79, 98304
    s_mul_i32 s82, s76, 229376
    s_add_u32 s82, s82, s40
    buffer_load_dwordx4 v88, s[48:51], s82 offen offset:0  lds
    v_mfma_f32_32x32x16_bf16 v[224:239], a[204:207], a[236:239], v[224:239]
    ds_read_b64_tr_b16 v[52:53], v74 offset:0
    v_and_b32 v123, 28, v123
    v_lshl_add_u32 v124, v123, 1, v124
    ds_read_b128 a[244:247], v112 offset:53248
    ds_read_b64_tr_b16 v[54:55], v74 offset:2048
    v_lshl_add_u32 v124, v3, 4, v124
    s_lshl_b32 s74, s75, 8
    s_nop 0
    v_mfma_f32_32x32x16_bf16 v[176:191], a[208:211], a[232:235], v[176:191]
    ds_read_b64_tr_b16 a[216:217], v97 offset:49152
    ds_read_b64_tr_b16 a[218:219], v97 offset:50176
    buffer_load_dwordx4 v89, s[48:51], s82 offen offset:1024  lds
    ds_read_b64_tr_b16 v[56:57], v75 offset:0
    v_mfma_f32_32x32x16_bf16 v[240:255], a[208:211], a[236:239], v[240:255]
    s_add_u32 s74, s74, s10
    ds_read_b64_tr_b16 a[220:221], v98 offset:49152
    ds_read_b64_tr_b16 v[58:59], v75 offset:2048
    v_add_u32 v70, s74, v124
    v_lshlrev_b32 v124, 5, v4
    s_waitcnt lgkmcnt(6)
    v_mfma_f32_32x32x16_bf16 v[128:143], a[212:215], a[240:243], v[128:143]
    ds_read_b64_tr_b16 a[222:223], v98 offset:50176
    buffer_load_dwordx4 v90, s[48:51], s82 offen offset:2048  lds
    v_lshlrev_b32_e64 v125, 4, v3
    v_mfma_f32_32x32x16_bf16 v[192:207], a[212:215], a[244:247], v[192:207]
    ds_read_b64_tr_b16 a[224:225], v99 offset:49152
    ds_read_b64_tr_b16 a[226:227], v99 offset:50176
    v_sub_u32_e64 v125, v125, v124
    s_add_u32 s74, s74, 17120
    s_waitcnt lgkmcnt(6)
    s_nop 0
    v_mfma_f32_32x32x16_bf16 v[144:159], a[216:219], a[240:243], v[144:159]
    ds_read_b128 a[248:251], v113 offset:49152
    buffer_load_dwordx4 v91, s[48:51], s82 offen offset:3072  lds
    v_mfma_f32_32x32x16_bf16 v[208:223], a[216:219], a[244:247], v[208:223]
    v_add_u32_e64 v71, s74, v125
    ds_read_b64_tr_b16 a[228:229], v96 offset:53248
    v_lshlrev_b32 v125, 3, v3
    v_add_u32 v125, v125, v124
    ds_read_b64_tr_b16 a[230:231], v96 offset:54272
    s_waitcnt lgkmcnt(3)
    v_mfma_f32_32x32x16_bf16 v[160:175], a[220:223], a[240:243], v[160:175]
    ds_read_b128 a[252:255], v113 offset:53248
    s_add_u32 m0, s79, 106496
    s_add_u32 s82, s82, s41
    buffer_load_dwordx4 v88, s[48:51], s82 offen offset:0  lds
    v_mfma_f32_32x32x16_bf16 v[224:239], a[220:223], a[244:247], v[224:239]
    s_lshl_b32 s74, s75, 11
    ds_read_b64_tr_b16 a[204:205], v97 offset:53248
    s_sub_u32 s74, s10, s74
    s_add_u32 s74, s74, 19192
    v_mfma_f32_32x32x16_bf16 v[176:191], a[224:227], a[240:243], v[176:191]
    ds_read_b64_tr_b16 a[206:207], v97 offset:54272
    buffer_load_dwordx4 v89, s[48:51], s82 offen offset:1024  lds
    v_sub_u32_e64 v69, s74, v125
    v_mfma_f32_32x32x16_bf16 v[240:255], a[224:227], a[244:247], v[240:255]
    ds_read_b64_tr_b16 a[208:209], v98 offset:53248
    ds_read_b64_tr_b16 a[210:211], v98 offset:54272
    v_and_b32_e64 v125, 1, v3
    v_lshl_add_u32 v124, v125, 9, v124
    s_waitcnt lgkmcnt(4)
    s_nop 0
    v_mfma_f32_32x32x16_bf16 v[128:143], a[228:231], a[248:251], v[128:143]
    ds_read_b64_tr_b16 a[212:213], v99 offset:53248
    buffer_load_dwordx4 v90, s[48:51], s82 offen offset:2048  lds
    v_mfma_f32_32x32x16_bf16 v[192:207], a[228:231], a[252:255], v[192:207]
    v_lshrrev_b32_e64 v125, 1, v3
    ds_read_b64_tr_b16 a[214:215], v99 offset:54272
    v_lshl_add_u32 v68, v125, 4, v124
    s_and_b32 s7, s4, 6
    s_waitcnt lgkmcnt(4)
    v_mfma_f32_32x32x16_bf16 v[144:159], a[204:207], a[248:251], v[144:159]
    ds_read_b128 a[232:235], v114 offset:49152
    ds_read_b64_tr_b16 a[216:217], v96 offset:57344
    buffer_load_dwordx4 v91, s[48:51], s82 offen offset:3072  lds
    v_mfma_f32_32x32x16_bf16 v[208:223], a[204:207], a[252:255], v[208:223]
    s_bfe_u32 s74, s5, 0x10001
    ds_read_b64_tr_b16 a[218:219], v96 offset:58368
    s_add_u32 s7, s7, s74
    s_lshl_b32 s7, s7, 12
    ds_read_b128 a[236:239], v114 offset:53248
    s_waitcnt lgkmcnt(4)
    s_nop 0
    v_mfma_f32_32x32x16_bf16 v[160:175], a[208:211], a[248:251], v[160:175]
    buffer_store_dwordx4 v[52:55], v122, s[64:67], s94 offen offset:0 sc1
    buffer_store_dwordx4 v[56:59], v122, s[64:67], s94 offen offset:1024 sc1
    v_mfma_f32_32x32x16_bf16 v[224:239], a[208:211], a[252:255], v[224:239]
    s_and_b32 s74, s5, 1
    ds_read_b64_tr_b16 a[220:221], v97 offset:57344
    ds_read_b64_tr_b16 a[222:223], v97 offset:58368
    s_xor_b32 s76, s70, 3
    s_mov_b32 m0, s80
    s_lshl_b32 s83, s76, 7
    v_mfma_f32_32x32x16_bf16 v[176:191], a[212:215], a[248:251], v[176:191]
    buffer_load_dwordx4 v84, s[36:39], s83 offen offset:0  lds
    s_lshl_b32 s74, s74, 11
    s_add_u32 s7, s7, s74
    ds_read_b64_tr_b16 a[224:225], v98 offset:57344
    v_mfma_f32_32x32x16_bf16 v[240:255], a[212:215], a[252:255], v[240:255]
    s_add_u32 s7, s7, 32768
    ds_read_b64_tr_b16 a[226:227], v98 offset:58368
    buffer_load_dwordx4 v85, s[36:39], s83 offen offset:1024  lds
    s_waitcnt lgkmcnt(4)
    v_mfma_f32_32x32x16_bf16 v[128:143], a[216:219], a[232:235], v[128:143]
    v_lshl_add_u32 v20, v4, 7, s7
    s_and_b32 s75, s4, 1
    ds_read_b64_tr_b16 a[228:229], v99 offset:57344
    ds_read_b64_tr_b16 a[230:231], v99 offset:58368
    s_lshl_b32 s75, s75, 12
    v_mfma_f32_32x32x16_bf16 v[192:207], a[216:219], a[236:239], v[192:207]
    ds_read_b128 a[240:243], v115 offset:49152
    buffer_load_dwordx4 v86, s[36:39], s83 offen offset:2048  lds
    s_waitcnt lgkmcnt(3)
    v_mfma_f32_32x32x16_bf16 v[144:159], a[220:223], a[232:235], v[144:159]
    s_lshl_b32 s74, s72, 9
    s_add_u32 s74, s74, s75
    ds_read_b64_tr_b16 a[204:205], v96 offset:61440
    s_add_u32 s74, s74, 32768
    v_mfma_f32_32x32x16_bf16 v[208:223], a[220:223], a[236:239], v[208:223]
    ds_read_b64_tr_b16 a[206:207], v96 offset:62464
    ds_read_b128 a[244:247], v115 offset:53248
    buffer_load_dwordx4 v87, s[36:39], s83 offen offset:3072  lds
    v_mfma_f32_32x32x16_bf16 v[160:175], a[224:227], a[232:235], v[160:175]
    v_lshlrev_b32_e64 v21, 13, v7
    v_lshl_add_u32 v21, v8, 7, v21
    ds_read_b64_tr_b16 a[208:209], v97 offset:61440
    v_add_u32_e64 v21, s74, v21
    ds_read_b64_tr_b16 a[210:211], v97 offset:62464
    v_mfma_f32_32x32x16_bf16 v[224:239], a[224:227], a[236:239], v[224:239]
    s_mov_b32 m0, s79
    s_mul_i32 s82, s76, 229376
    s_add_u32 s82, s82, s40
    buffer_load_dwordx4 v88, s[48:51], s82 offen offset:0  lds
    s_waitcnt lgkmcnt(3)
    v_mfma_f32_32x32x16_bf16 v[176:191], a[228:231], a[232:235], v[176:191]
    v_cmp_gt_u32 vcc, 16, v1
    s_nop 1
    v_cndmask_b32 v20, v21, v20, vcc
    ds_read_b64_tr_b16 a[212:213], v98 offset:61440
    ds_read_b64_tr_b16 a[214:215], v98 offset:62464
    v_and_b32_e64 v22, 31, v1
    v_mfma_f32_32x32x16_bf16 v[240:255], a[228:231], a[236:239], v[240:255]
    ds_read_b64_tr_b16 a[216:217], v99 offset:61440
    buffer_load_dwordx4 v89, s[48:51], s82 offen offset:1024  lds
    v_mfma_f32_32x32x16_bf16 v[128:143], a[204:207], a[240:243], v[128:143]
    v_lshlrev_b32 v23, 3, v22
    s_and_b32 s74, s3, 2
    ds_read_b64_tr_b16 a[218:219], v99 offset:62464
    s_lshl_b32 s74, s74, 9
    s_waitcnt lgkmcnt(4)
    v_mfma_f32_32x32x16_bf16 v[192:207], a[204:207], a[244:247], v[192:207]
    buffer_load_dwordx4 v90, s[48:51], s82 offen offset:2048  lds
    v_mfma_f32_32x32x16_bf16 v[144:159], a[208:211], a[240:243], v[144:159]
    s_add_u32 s74, s74, 157696
    v_add_u32 v23, s74, v23
    s_lshl_b32 s7, s69, 10
    v_mfma_f32_32x32x16_bf16 v[208:223], a[208:211], a[244:247], v[208:223]
    s_waitcnt vmcnt(9) lgkmcnt(0)
    s_barrier
    ds_read_b128 a[248:251], v116 offset:0
    ds_read_b64_tr_b16 a[220:221], v100 offset:0
    buffer_load_dwordx4 v91, s[48:51], s82 offen offset:3072  lds
    s_and_b32 s74, s3, 1
    s_lshl_b32 s74, s74, 9
    v_mfma_f32_32x32x16_bf16 v[160:175], a[212:215], a[240:243], v[160:175]
    ds_read_b64_tr_b16 a[222:223], v100 offset:1024
    s_add_u32 s7, s7, s74
    ds_read_b128 a[252:255], v116 offset:4096
    s_add_u32 m0, s79, 8192
    v_mfma_f32_32x32x16_bf16 v[224:239], a[212:215], a[244:247], v[224:239]
    s_add_u32 s82, s82, s41
    buffer_load_dwordx4 v88, s[48:51], s82 offen offset:0  lds
    v_mfma_f32_32x32x16_bf16 v[176:191], a[216:219], a[240:243], v[176:191]
    s_add_u32 s7, s7, 262144
    v_lshl_add_u32 v22, v22, 3, s7
    ds_read_b64_tr_b16 a[224:225], v101 offset:0
    ds_read_b64_tr_b16 a[226:227], v101 offset:1024
    s_lshl_b32 s7, s3, 10
    v_mfma_f32_32x32x16_bf16 v[240:255], a[216:219], a[244:247], v[240:255]
    ds_read_b64_tr_b16 a[228:229], v102 offset:0
    buffer_load_dwordx4 v89, s[48:51], s82 offen offset:1024  lds
    s_waitcnt lgkmcnt(3)
    v_mfma_f32_32x32x16_bf16 v[128:143], a[220:223], a[248:251], v[128:143]
    s_add_u32 s7, s7, 159744
    v_add_u32_e64 v16, s7, v122
    ds_read_b64_tr_b16 a[230:231], v102 offset:1024
    v_lshlrev_b32_e64 v17, 2, v0
    v_mfma_f32_32x32x16_bf16 v[192:207], a[220:223], a[252:255], v[192:207]
    ds_read_b64_tr_b16 a[204:205], v103 offset:0
    ds_read_b64_tr_b16 a[206:207], v103 offset:1024
    buffer_load_dwordx4 v90, s[48:51], s82 offen offset:2048  lds
    s_waitcnt lgkmcnt(4)
    v_mfma_f32_32x32x16_bf16 v[144:159], a[224:227], a[248:251], v[144:159]
    v_lshlrev_b32 v19, 1, v17
    v_add_u32 v17, 159744, v17
    ds_read_b128 a[232:235], v117 offset:0
    v_add_u32 v19, 157696, v19
    v_mfma_f32_32x32x16_bf16 v[208:223], a[224:227], a[252:255], v[208:223]
    ds_read_b64_tr_b16 a[208:209], v100 offset:4096
    buffer_load_dwordx4 v91, s[48:51], s82 offen offset:3072  lds
    s_lshl_b32 s7, s68, 14
    s_waitcnt lgkmcnt(4)
    v_mfma_f32_32x32x16_bf16 v[160:175], a[228:231], a[248:251], v[160:175]
    s_lshl_b32 s74, s3, 12
    ds_read_b64_tr_b16 a[210:211], v100 offset:5120
    ds_read_b128 a[236:239], v117 offset:4096
    s_add_u32 s7, s7, s74
    ds_read_b64_tr_b16 a[212:213], v101 offset:4096
    v_mfma_f32_32x32x16_bf16 v[224:239], a[228:231], a[252:255], v[224:239]
    s_xor_b32 s76, s70, 4
    s_add_u32 m0, s80, 49152
    s_lshl_b32 s83, s76, 7
    buffer_load_dwordx4 v84, s[36:39], s83 offen offset:0  lds
    s_waitcnt lgkmcnt(5)
    v_mfma_f32_32x32x16_bf16 v[176:191], a[204:207], a[248:251], v[176:191]
    s_add_u32 s42, s7, 294912
    v_or_b32 v20, s20, v20
    ds_read_b64_tr_b16 a[214:215], v101 offset:5120
    v_min_u32_e64 v73, 6, v6
    v_mfma_f32_32x32x16_bf16 v[240:255], a[204:207], a[252:255], v[240:255]
    ds_read_b64_tr_b16 a[216:217], v102 offset:4096
    ds_read_b64_tr_b16 a[218:219], v102 offset:5120
    buffer_load_dwordx4 v85, s[36:39], s83 offen offset:1024  lds
    s_waitcnt lgkmcnt(4)
    v_mfma_f32_32x32x16_bf16 v[128:143], a[208:211], a[232:235], v[128:143]
    v_lshl_add_u32 v73, v5, 3, v73
    s_lshr_b32 s7, s72, 1
    ds_read_b64_tr_b16 a[220:221], v103 offset:4096
    s_lshl_b32 s7, s7, 7
    s_nop 0
    v_mfma_f32_32x32x16_bf16 v[192:207], a[208:211], a[236:239], v[192:207]
    ds_read_b64_tr_b16 a[222:223], v103 offset:5120
    buffer_load_dwordx4 v86, s[36:39], s83 offen offset:2048  lds
    s_add_u32 s7, s7, 32768
    s_waitcnt lgkmcnt(4)
    s_nop 0
    v_mfma_f32_32x32x16_bf16 v[144:159], a[212:215], a[232:235], v[144:159]
    v_lshl_add_u32 v72, v73, 9, s7
    ds_read_b128 a[240:243], v118 offset:0
    ds_read_b64_tr_b16 a[224:225], v100 offset:8192
    v_or_b32_e64 v72, s20, v72
    v_mfma_f32_32x32x16_bf16 v[208:223], a[212:215], a[236:239], v[208:223]
    ds_read_b64_tr_b16 a[226:227], v100 offset:9216
    buffer_load_dwordx4 v87, s[36:39], s83 offen offset:3072  lds
    s_waitcnt lgkmcnt(3)
    v_mfma_f32_32x32x16_bf16 v[160:175], a[216:219], a[232:235], v[160:175]
    s_mov_b32 s86, 0
    s_mov_b32 s87, 4096
    ds_read_b128 a[244:247], v118 offset:4096
    s_mov_b32 s88, 8192
    v_mfma_f32_32x32x16_bf16 v[224:239], a[216:219], a[236:239], v[224:239]
    ds_read_b64_tr_b16 a[228:229], v101 offset:8192
    ds_read_b64_tr_b16 a[230:231], v101 offset:9216
    s_add_u32 m0, s79, 49152
    s_mul_i32 s82, s76, 229376
    s_add_u32 s82, s82, s40
    s_nop 0
    v_mfma_f32_32x32x16_bf16 v[176:191], a[220:223], a[232:235], v[176:191]
    buffer_load_dwordx4 v88, s[48:51], s82 offen offset:0  lds
    s_mov_b32 s89, 12288
    s_mov_b32 s90, 16384
    ds_read_b64_tr_b16 a[204:205], v102 offset:8192
    v_mfma_f32_32x32x16_bf16 v[240:255], a[220:223], a[236:239], v[240:255]
    s_mov_b32 s91, 20480
    ds_read_b64_tr_b16 a[206:207], v102 offset:9216
    buffer_load_dwordx4 v89, s[48:51], s82 offen offset:1024  lds
    s_waitcnt lgkmcnt(4)
    s_nop 0
    v_mfma_f32_32x32x16_bf16 v[128:143], a[224:227], a[240:243], v[128:143]
    s_mov_b32 s92, 24576
    s_mul_i32 s11, s71, 229376
    ds_read_b64_tr_b16 a[208:209], v103 offset:8192
    ds_read_b64_tr_b16 a[210:211], v103 offset:9216
    s_mul_i32 s74, s3, 28672
    v_mfma_f32_32x32x16_bf16 v[192:207], a[224:227], a[244:247], v[192:207]
    ds_read_b128 a[248:251], v119 offset:0
    buffer_load_dwordx4 v90, s[48:51], s82 offen offset:2048  lds
    s_waitcnt lgkmcnt(3)
    v_mfma_f32_32x32x16_bf16 v[144:159], a[228:231], a[240:243], v[144:159]
    s_add_u32 s11, s11, s74
    s_add_u32 s11, s11, 6291456
    ds_read_b64_tr_b16 a[212:213], v100 offset:12288
    v_lshrrev_b32_e64 v124, 1, v3
    v_mfma_f32_32x32x16_bf16 v[208:223], a[228:231], a[244:247], v[208:223]
    ds_read_b64_tr_b16 a[214:215], v100 offset:13312
    ds_read_b128 a[252:255], v119 offset:4096
    buffer_load_dwordx4 v91, s[48:51], s82 offen offset:3072  lds
    v_mfma_f32_32x32x16_bf16 v[160:175], a[204:207], a[240:243], v[160:175]
    v_lshlrev_b32 v124, 10, v124
    v_and_b32 v125, 1, v3
    ds_read_b64_tr_b16 a[216:217], v101 offset:12288
    v_lshl_add_u32 v124, v125, 9, v124
    ds_read_b64_tr_b16 a[218:219], v101 offset:13312
    v_mfma_f32_32x32x16_bf16 v[224:239], a[204:207], a[244:247], v[224:239]
    s_add_u32 m0, s79, 57344
    s_add_u32 s82, s82, s41
    buffer_load_dwordx4 v88, s[48:51], s82 offen offset:0  lds
    s_waitcnt lgkmcnt(3)
    v_mfma_f32_32x32x16_bf16 v[176:191], a[208:211], a[240:243], v[176:191]
    v_lshl_add_u32 v124, v4, 4, v124
    v_add_u32_e64 v9, s11, v124
    ds_read_b64_tr_b16 a[220:221], v102 offset:12288
    ds_read_b64_tr_b16 a[222:223], v102 offset:13312
    v_add_u32 v18, 114688, v9
    v_mfma_f32_32x32x16_bf16 v[240:255], a[208:211], a[244:247], v[240:255]
    ds_read_b64_tr_b16 a[224:225], v103 offset:12288
    buffer_load_dwordx4 v89, s[48:51], s82 offen offset:1024  lds
    v_mfma_f32_32x32x16_bf16 v[128:143], a[212:215], a[248:251], v[128:143]
    s_mul_i32 s93, s72, 229376
    s_mul_i32 s74, s3, 57344
    ds_read_b64_tr_b16 a[226:227], v103 offset:13312
    s_add_u32 s93, s93, s74
    s_waitcnt lgkmcnt(4)
    v_mfma_f32_32x32x16_bf16 v[192:207], a[212:215], a[252:255], v[192:207]
    buffer_load_dwordx4 v90, s[48:51], s82 offen offset:2048  lds
    s_add_u32 s93, s93, 14155776
    v_mfma_f32_32x32x16_bf16 v[144:159], a[216:219], a[248:251], v[144:159]
    s_lshl_b32 s7, s71, 16
    s_lshl_b32 s74, s72, 7
    s_add_u32 s7, s7, s74
    v_mfma_f32_32x32x16_bf16 v[208:223], a[216:219], a[252:255], v[208:223]
    s_waitcnt vmcnt(11) lgkmcnt(0)
    s_barrier
    ds_read_b128 a[232:235], v112 offset:0
    ds_read_b64_tr_b16 a[228:229], v96 offset:0
    buffer_load_dwordx4 v91, s[48:51], s82 offen offset:3072  lds
    s_lshl_b32 s74, s3, 14
    v_mfma_f32_32x32x16_bf16 v[160:175], a[220:223], a[248:251], v[160:175]
    ds_read_b64_tr_b16 a[230:231], v96 offset:1024
    s_or_b32 s78, s95, s20
    v_mov_b32 v10, s78
    v_mov_b32 v11, s6
    s_mov_b64 exec, 1
    buffer_store_dword v11, v10, s[64:67], 0 offen sc1
    s_mov_b64 exec, -1
    s_add_u32 s46, s7, s74
    s_lshl_b32 s74, s3, 5
    v_mfma_f32_32x32x16_bf16 v[224:239], a[220:223], a[252:255], v[224:239]
    ds_read_b128 a[236:239], v112 offset:4096
    s_xor_b32 s76, s70, 5
    s_add_u32 m0, s80, 98304
    s_lshl_b32 s83, s76, 7
    buffer_load_dwordx4 v84, s[36:39], s83 offen offset:0  lds
    v_mfma_f32_32x32x16_bf16 v[176:191], a[224:227], a[248:251], v[176:191]
    s_add_u32 s7, s7, s74
    ds_read_b64_tr_b16 a[204:205], v97 offset:0
    ds_read_b64_tr_b16 a[206:207], v97 offset:1024
    v_lshlrev_b32_e64 v124, 10, v4
    v_lshl_add_u32 v124, v3, 3, v124
    v_mfma_f32_32x32x16_bf16 v[240:255], a[224:227], a[252:255], v[240:255]
    ds_read_b64_tr_b16 a[208:209], v98 offset:0
    buffer_load_dwordx4 v85, s[36:39], s83 offen offset:1024  lds
    s_waitcnt lgkmcnt(3)
    v_mfma_f32_32x32x16_bf16 v[128:143], a[228:231], a[232:235], v[128:143]
    v_add_u32 v64, s7, v124
    ds_read_b64_tr_b16 a[210:211], v98 offset:1024
    s_lshl_b32 s7, s71, 9
    s_nop 0
    s_add_u32 s7, s7, 262144
    v_mfma_f32_32x32x16_bf16 v[192:207], a[228:231], a[236:239], v[192:207]
    ds_read_b64_tr_b16 a[212:213], v99 offset:0
    ds_read_b64_tr_b16 a[214:215], v99 offset:1024
    buffer_load_dwordx4 v86, s[36:39], s83 offen offset:2048  lds
    s_waitcnt lgkmcnt(4)
    v_mfma_f32_32x32x16_bf16 v[144:159], a[204:207], a[232:235], v[144:159]
    v_lshl_add_u32 v65, v4, 3, s7
    ds_read_b128 a[240:243], v113 offset:0
    v_xor_b32 v124, v6, v5
    v_lshlrev_b32_e64 v124, 4, v124
    v_mfma_f32_32x32x16_bf16 v[208:223], a[204:207], a[236:239], v[208:223]
    ds_read_b64_tr_b16 a[216:217], v96 offset:4096
    buffer_load_dwordx4 v87, s[36:39], s83 offen offset:3072  lds
    v_lshl_add_u32 v67, v5, 10, v124
    s_waitcnt lgkmcnt(4)
    s_nop 0
    v_mfma_f32_32x32x16_bf16 v[160:175], a[208:211], a[232:235], v[160:175]
    ds_read_b64_tr_b16 a[218:219], v96 offset:5120
    ds_read_b128 a[244:247], v113 offset:4096
    v_add_u32 v76, 7168, v67
    v_lshrrev_b32_e64 v124, 1, v3
    ds_read_b64_tr_b16 a[220:221], v97 offset:4096
    v_mfma_f32_32x32x16_bf16 v[224:239], a[208:211], a[236:239], v[224:239]
    s_add_u32 m0, s79, 98304
    s_mul_i32 s82, s76, 229376
    s_add_u32 s82, s82, s40
    buffer_load_dwordx4 v88, s[48:51], s82 offen offset:0  lds
    s_waitcnt lgkmcnt(5)
    v_mfma_f32_32x32x16_bf16 v[176:191], a[212:215], a[232:235], v[176:191]
    v_lshl_add_u32 v124, s3, 1, v124
    ds_read_b64_tr_b16 a[222:223], v97 offset:5120
    v_xor_b32 v124, v124, v6
    v_lshlrev_b32 v124, 4, v124
    v_mfma_f32_32x32x16_bf16 v[240:255], a[212:215], a[236:239], v[240:255]
    ds_read_b64_tr_b16 a[224:225], v98 offset:4096
    ds_read_b64_tr_b16 a[226:227], v98 offset:5120
    buffer_load_dwordx4 v89, s[48:51], s82 offen offset:1024  lds
    s_waitcnt lgkmcnt(4)
    s_nop 0
    v_mfma_f32_32x32x16_bf16 v[128:143], a[216:219], a[240:243], v[128:143]
    v_lshl_add_u32 v124, v4, 7, v124
    ds_read_b64_tr_b16 a[228:229], v99 offset:4096
    v_lshl_add_u32 v124, v125, 3, v124
    v_add_u32 v77, 65536, v124
    v_mfma_f32_32x32x16_bf16 v[192:207], a[216:219], a[244:247], v[192:207]
    ds_read_b64_tr_b16 a[230:231], v99 offset:5120
    buffer_load_dwordx4 v90, s[48:51], s82 offen offset:2048  lds
    s_lshl_b32 s7, s72, 6
    s_waitcnt lgkmcnt(4)
    v_mfma_f32_32x32x16_bf16 v[144:159], a[220:223], a[240:243], v[144:159]
    ds_read_b128 a[248:251], v114 offset:0
    ds_read_b64_tr_b16 a[204:205], v96 offset:8192
    s_lshl_b32 s74, s3, 4
    s_add_u32 s7, s7, s74
    v_mfma_f32_32x32x16_bf16 v[208:223], a[220:223], a[244:247], v[208:223]
    ds_read_b64_tr_b16 a[206:207], v96 offset:9216
    buffer_load_dwordx4 v91, s[48:51], s82 offen offset:3072  lds
    s_waitcnt lgkmcnt(3)
    v_mfma_f32_32x32x16_bf16 v[160:175], a[224:227], a[240:243], v[160:175]
    s_mul_i32 s7, s7, 4224
    ds_read_b128 a[252:255], v114 offset:4096
    s_lshl_b32 s74, s71, 7
    s_add_u32 s7, s7, s74
    s_nop 0
    ds_read_b64_tr_b16 a[208:209], v97 offset:8192
    v_mfma_f32_32x32x16_bf16 v[224:239], a[224:227], a[244:247], v[224:239]
    ds_read_b64_tr_b16 a[210:211], v97 offset:9216
    s_add_u32 m0, s79, 106496
    s_add_u32 s82, s82, s41
    s_nop 0
    buffer_load_dwordx4 v88, s[48:51], s82 offen offset:0  lds
    v_mfma_f32_32x32x16_bf16 v[176:191], a[228:231], a[240:243], v[176:191]
    s_add_u32 s16, s7, 3276800
    ds_read_b64_tr_b16 a[212:213], v98 offset:8192
    s_add_u32 s17, s16, 33792
    v_mul_u32_u24 v124, 4224, v5
    v_mfma_f32_32x32x16_bf16 v[240:255], a[228:231], a[244:247], v[240:255]
    ds_read_b64_tr_b16 a[214:215], v98 offset:9216
    buffer_load_dwordx4 v89, s[48:51], s82 offen offset:1024  lds
    v_lshl_add_u32 v78, v6, 4, v124
    s_waitcnt lgkmcnt(4)
    s_nop 0
    v_mfma_f32_32x32x16_bf16 v[128:143], a[204:207], a[248:251], v[128:143]
    ds_read_b64_tr_b16 a[216:217], v99 offset:8192
    ds_read_b64_tr_b16 a[218:219], v99 offset:9216
    s_mul_i32 s7, s3, 2560
    s_add_u32 s7, s7, 32768
    v_mfma_f32_32x32x16_bf16 v[192:207], a[204:207], a[252:255], v[192:207]
    ds_read_b128 a[232:235], v115 offset:0
    buffer_load_dwordx4 v90, s[48:51], s82 offen offset:2048  lds
    s_waitcnt lgkmcnt(3)
    s_nop 0
    v_mfma_f32_32x32x16_bf16 v[144:159], a[208:211], a[248:251], v[144:159]
    v_mul_u32_u24 v124, 160, v5
    ds_read_b64_tr_b16 a[220:221], v96 offset:12288
    v_lshl_add_u32 v124, v6, 4, v124
    v_add_u32_e64 v79, s7, v124
    ds_read_b64_tr_b16 a[222:223], v96 offset:13312
    v_mfma_f32_32x32x16_bf16 v[208:223], a[208:211], a[252:255], v[208:223]
    ds_read_b128 a[236:239], v115 offset:4096
    buffer_load_dwordx4 v91, s[48:51], s82 offen offset:3072  lds
    v_lshl_add_u32 v124, v3, 2, v7
    v_mfma_f32_32x32x16_bf16 v[160:175], a[212:215], a[248:251], v[160:175]
    ds_read_b64_tr_b16 a[224:225], v97 offset:12288
    v_mul_u32_u24 v124, 160, v124
    v_lshl_add_u32 v124, v8, 3, v124
    buffer_load_dwordx4 v[32:35], v122, s[52:55], s31 offen offset:0
    v_mfma_f32_32x32x16_bf16 v[224:239], a[212:215], a[252:255], v[224:239]
    ds_read_b64_tr_b16 a[226:227], v97 offset:13312
    v_add_u32_e64 v80, s7, v124
    buffer_load_dwordx4 v[36:39], v122, s[52:55], s31 offen offset:8
    s_waitcnt lgkmcnt(3)
    v_mfma_f32_32x32x16_bf16 v[176:191], a[216:219], a[248:251], v[176:191]
    ds_read_b64_tr_b16 a[228:229], v98 offset:12288
    ds_read_b64_tr_b16 a[230:231], v98 offset:13312
    s_lshl_b32 s7, s72, 12
    s_add_u32 s7, s7, 65536
    v_mfma_f32_32x32x16_bf16 v[240:255], a[216:219], a[252:255], v[240:255]
    ds_read_b64_tr_b16 a[204:205], v99 offset:12288
    s_or_b32 s7, s7, s20
    buffer_load_dwordx4 v[40:43], v122, s[52:55], s31 offen offset:1024
    v_mfma_f32_32x32x16_bf16 v[128:143], a[220:223], a[232:235], v[128:143]
    ds_read_b64_tr_b16 a[206:207], v99 offset:13312
    v_and_b32 v124, 31, v1
    v_lshl_add_u32 v81, v124, 7, s7
    s_waitcnt lgkmcnt(4)
    v_mfma_f32_32x32x16_bf16 v[192:207], a[220:223], a[236:239], v[192:207]
    s_lshl_b32 s7, s71, 13
    buffer_load_dwordx4 v[44:47], v122, s[52:55], s31 offen offset:1032
    v_mfma_f32_32x32x16_bf16 v[144:159], a[224:227], a[232:235], v[144:159]
    s_add_u32 s7, s7, 786432
    s_or_b32 s7, s7, s20
    v_mfma_f32_32x32x16_bf16 v[208:223], a[224:227], a[236:239], v[208:223]
    s_waitcnt vmcnt(17) lgkmcnt(0)
    s_barrier
    ds_read_b128 a[240:243], v112 offset:49152
    ds_read_b64_tr_b16 a[208:209], v96 offset:49152
    v_min_u32 v124, 27, v1
    v_mfma_f32_32x32x16_bf16 v[160:175], a[228:231], a[232:235], v[160:175]
    ds_read_b64_tr_b16 a[210:211], v96 offset:50176
    s_xor_b32 s76, s70, 6
    s_mov_b32 m0, s80
    s_lshl_b32 s83, s76, 7
    buffer_load_dwordx4 v84, s[36:39], s83 offen offset:0  lds
    v_mfma_f32_32x32x16_bf16 v[224:239], a[228:231], a[236:239], v[224:239]
    v_lshl_add_u32 v82, v124, 7, s7
    s_lshr_b32 s7, s4, 2
    ds_read_b128 a[244:247], v112 offset:53248
    s_lshl_b32 s7, s7, 7
    s_nop 0
    v_mfma_f32_32x32x16_bf16 v[176:191], a[204:207], a[232:235], v[176:191]
    ds_read_b64_tr_b16 a[212:213], v97 offset:49152
    ds_read_b64_tr_b16 a[214:215], v97 offset:50176
    buffer_load_dwordx4 v85, s[36:39], s83 offen offset:1024  lds
    v_mfma_f32_32x32x16_bf16 v[240:255], a[204:207], a[236:239], v[240:255]
    s_add_u32 s7, s7, 8192
    s_or_b32 s7, s7, s20
    ds_read_b64_tr_b16 a[216:217], v98 offset:49152
    v_lshl_add_u32 v83, v4, 8, s7
    s_waitcnt lgkmcnt(3)
    v_mfma_f32_32x32x16_bf16 v[128:143], a[208:211], a[240:243], v[128:143]
    ds_read_b64_tr_b16 a[218:219], v98 offset:50176
    buffer_load_dwordx4 v86, s[36:39], s83 offen offset:2048  lds
    s_lshl_b32 s7, s3, 12
    s_nop 0
    v_mfma_f32_32x32x16_bf16 v[192:207], a[208:211], a[244:247], v[192:207]
    s_add_u32 s74, s7, 49152
    ds_read_b64_tr_b16 a[220:221], v99 offset:49152
    ds_read_b64_tr_b16 a[222:223], v99 offset:50176
    v_add_u32 v95, s74, v122
    s_waitcnt lgkmcnt(4)
    v_mfma_f32_32x32x16_bf16 v[144:159], a[212:215], a[240:243], v[144:159]
    ds_read_b128 a[248:251], v113 offset:49152
    buffer_load_dwordx4 v87, s[36:39], s83 offen offset:3072  lds
    v_mfma_f32_32x32x16_bf16 v[208:223], a[212:215], a[244:247], v[208:223]
    v_xor_b32 v120, 4096, v95
    s_add_u32 s74, s7, 0
    ds_read_b64_tr_b16 a[224:225], v96 offset:53248
    v_add_u32 v123, s74, v122
    s_waitcnt lgkmcnt(4)
    v_mfma_f32_32x32x16_bf16 v[160:175], a[216:219], a[240:243], v[160:175]
    ds_read_b64_tr_b16 a[226:227], v96 offset:54272
    ds_read_b128 a[252:255], v113 offset:53248
    s_mov_b32 m0, s79
    s_mul_i32 s82, s76, 229376
    s_add_u32 s82, s82, s40
    v_mfma_f32_32x32x16_bf16 v[224:239], a[216:219], a[244:247], v[224:239]
    buffer_load_dwordx4 v88, s[48:51], s82 offen offset:0  lds
    s_lshl_b32 s7, s3, 10
    s_add_u32 s74, s7, 0
    ds_read_b64_tr_b16 a[228:229], v97 offset:53248
    s_waitcnt lgkmcnt(5)
    v_mfma_f32_32x32x16_bf16 v[176:191], a[220:223], a[240:243], v[176:191]
    v_add_u32_e64 v121, s74, v122
    ds_read_b64_tr_b16 a[230:231], v97 offset:54272
    buffer_load_dwordx4 v89, s[48:51], s82 offen offset:1024  lds
    v_mfma_f32_32x32x16_bf16 v[240:255], a[220:223], a[244:247], v[240:255]
    s_lshl_b32 s14, s3, 11
    s_add_u32 s14, s14, 65536
    ds_read_b64_tr_b16 a[204:205], v98 offset:53248
    ds_read_b64_tr_b16 a[206:207], v98 offset:54272
    s_lshl_b32 s7, s85, 16
    s_waitcnt lgkmcnt(4)
    s_nop 0
    v_mfma_f32_32x32x16_bf16 v[128:143], a[224:227], a[248:251], v[128:143]
    ds_read_b64_tr_b16 a[208:209], v99 offset:53248
    buffer_load_dwordx4 v90, s[48:51], s82 offen offset:2048  lds
    s_and_b32 s74, s85, 0xffff0000
    v_mfma_f32_32x32x16_bf16 v[192:207], a[224:227], a[252:255], v[192:207]
    s_bitcmp1_b32 s73, 0
    s_cselect_b32 s45, s74, s7
    ds_read_b64_tr_b16 a[210:211], v99 offset:54272
    s_lshl_b32 s43, s4, 12
    s_waitcnt lgkmcnt(4)
    v_mfma_f32_32x32x16_bf16 v[144:159], a[228:231], a[248:251], v[144:159]
    ds_read_b128 a[232:235], v114 offset:49152
    ds_read_b64_tr_b16 a[212:213], v96 offset:57344
    buffer_load_dwordx4 v91, s[48:51], s82 offen offset:3072  lds
    v_mfma_f32_32x32x16_bf16 v[208:223], a[228:231], a[252:255], v[208:223]
    s_lshl_b32 s74, s5, 7
    s_add_u32 s43, s43, s74
    ds_read_b64_tr_b16 a[214:215], v96 offset:58368
    s_add_u32 s43, s43, 65536
    ds_read_b128 a[236:239], v114 offset:53248
    s_waitcnt lgkmcnt(4)
    v_mfma_f32_32x32x16_bf16 v[160:175], a[204:207], a[248:251], v[160:175]
    s_add_u32 m0, s79, 8192
    s_add_u32 s82, s82, s41
    buffer_load_dwordx4 v88, s[48:51], s82 offen offset:0  lds
    v_mfma_f32_32x32x16_bf16 v[224:239], a[204:207], a[252:255], v[224:239]
    s_lshl_b32 s7, s69, 1
    s_and_b32 s74, s3, 1
    ds_read_b64_tr_b16 a[216:217], v97 offset:57344
    ds_read_b64_tr_b16 a[218:219], v97 offset:58368
    s_add_u32 s7, s7, s74
    s_nop 0
    v_mfma_f32_32x32x16_bf16 v[176:191], a[208:211], a[248:251], v[176:191]
    ds_read_b64_tr_b16 a[220:221], v98 offset:57344
    buffer_load_dwordx4 v89, s[48:51], s82 offen offset:1024  lds
    v_mfma_f32_32x32x16_bf16 v[240:255], a[208:211], a[252:255], v[240:255]
    s_lshl_b32 s74, s68, 1
    s_lshr_b32 s75, s3, 1
    ds_read_b64_tr_b16 a[222:223], v98 offset:58368
    s_add_u32 s74, s74, s75
    s_waitcnt lgkmcnt(4)
    v_mfma_f32_32x32x16_bf16 v[128:143], a[212:215], a[232:235], v[128:143]
    ds_read_b64_tr_b16 a[224:225], v99 offset:57344
    ds_read_b64_tr_b16 a[226:227], v99 offset:58368
    buffer_load_dwordx4 v90, s[48:51], s82 offen offset:2048  lds
    v_mfma_f32_32x32x16_bf16 v[192:207], a[212:215], a[236:239], v[192:207]
    s_mul_i32 s75, s7, 224
    s_lshl_b32 s84, s7, 6
    ds_read_b128 a[240:243], v115 offset:49152
    s_add_u32 s84, s84, s74
    s_waitcnt lgkmcnt(3)
    v_mfma_f32_32x32x16_bf16 v[144:159], a[216:219], a[232:235], v[144:159]
    ds_read_b64_tr_b16 a[228:229], v96 offset:61440
    buffer_load_dwordx4 v91, s[48:51], s82 offen offset:3072  lds
    s_lshl_b32 s84, s84, 7
    v_mfma_f32_32x32x16_bf16 v[208:223], a[216:219], a[236:239], v[208:223]
    s_add_u32 s84, s84, 786432
    ds_read_b64_tr_b16 a[230:231], v96 offset:62464
    ds_read_b128 a[244:247], v115 offset:53248
    s_lshl_b32 s74, s74, 2
    v_mfma_f32_32x32x16_bf16 v[160:175], a[220:223], a[232:235], v[160:175]
    ds_read_b64_tr_b16 a[204:205], v97 offset:61440
    s_add_u32 s75, s75, s74
    s_lshl_b32 s75, s75, 10
    s_nop 0
    v_mfma_f32_32x32x16_bf16 v[224:239], a[220:223], a[236:239], v[224:239]
    ds_read_b64_tr_b16 a[206:207], v97 offset:62464
    s_add_u32 s44, s75, 6291456
    ds_read_b64_tr_b16 a[208:209], v98 offset:61440
    s_waitcnt lgkmcnt(4)
    s_nop 0
    v_mfma_f32_32x32x16_bf16 v[176:191], a[224:227], a[232:235], v[176:191]
    ds_read_b64_tr_b16 a[210:211], v98 offset:62464
    buffer_load_dword v21, v20, s[64:67], 0 offen sc1
    v_mfma_f32_32x32x16_bf16 v[240:255], a[224:227], a[236:239], v[240:255]
    buffer_load_dword v73, v72, s[64:67], 0 offen sc1
    v_mfma_f32_32x32x16_bf16 v[128:143], a[228:231], a[240:243], v[128:143]
    ds_read_b64_tr_b16 a[212:213], v99 offset:61440
    s_waitcnt lgkmcnt(3)
    s_nop 0
    v_mfma_f32_32x32x16_bf16 v[192:207], a[228:231], a[244:247], v[192:207]
    ds_read_b64_tr_b16 a[214:215], v99 offset:62464
    v_mfma_f32_32x32x16_bf16 v[144:159], a[204:207], a[240:243], v[144:159]
    v_mfma_f32_32x32x16_bf16 v[208:223], a[204:207], a[244:247], v[208:223]
    s_waitcnt vmcnt(18) lgkmcnt(0)
    s_barrier
    ds_read_b128 a[248:251], v116 offset:0
    ds_read_b64_tr_b16 a[216:217], v100 offset:0
    v_mfma_f32_32x32x16_bf16 v[160:175], a[208:211], a[240:243], v[160:175]
    ds_read_b64_tr_b16 a[218:219], v100 offset:1024
    s_xor_b32 s76, s70, 7
    s_add_u32 m0, s80, 49152
    s_lshl_b32 s83, s76, 7
    v_mfma_f32_32x32x16_bf16 v[224:239], a[208:211], a[244:247], v[224:239]
    buffer_load_dwordx4 v84, s[36:39], s83 offen offset:0  lds
    ds_read_b128 a[252:255], v116 offset:4096
    s_waitcnt vmcnt(18)
    s_nop 0
    v_alignbit_b32 v48, v33, v32, 16
    v_mfma_f32_32x32x16_bf16 v[176:191], a[212:215], a[240:243], v[176:191]
    ds_read_b64_tr_b16 a[220:221], v101 offset:0
    ds_read_b64_tr_b16 a[222:223], v101 offset:1024
    buffer_load_dwordx4 v85, s[36:39], s83 offen offset:1024  lds
    v_mfma_f32_32x32x16_bf16 v[240:255], a[212:215], a[244:247], v[240:255]
    v_alignbit_b32 v49, v34, v33, 16
    ds_read_b64_tr_b16 a[224:225], v102 offset:0
    v_alignbit_b32 v50, v35, v34, 16
    s_waitcnt lgkmcnt(3)
    s_nop 0
    v_mfma_f32_32x32x16_bf16 v[128:143], a[216:219], a[248:251], v[128:143]
    ds_read_b64_tr_b16 a[226:227], v102 offset:1024
    buffer_load_dwordx4 v86, s[36:39], s83 offen offset:2048  lds
    v_mfma_f32_32x32x16_bf16 v[192:207], a[216:219], a[252:255], v[192:207]
    s_waitcnt vmcnt(19)
    s_nop 0
    v_alignbit_b32 v51, v38, v35, 16
    ds_read_b64_tr_b16 a[228:229], v103 offset:0
    ds_read_b64_tr_b16 a[230:231], v103 offset:1024
    v_alignbit_b32 v52, v34, v33, 16
    s_waitcnt lgkmcnt(4)
    s_nop 0
    v_mfma_f32_32x32x16_bf16 v[144:159], a[220:223], a[248:251], v[144:159]
    ds_read_b128 a[232:235], v117 offset:0
    buffer_load_dwordx4 v87, s[36:39], s83 offen offset:3072  lds
    v_mfma_f32_32x32x16_bf16 v[208:223], a[220:223], a[252:255], v[208:223]
    v_alignbit_b32 v53, v35, v34, 16
    ds_read_b64_tr_b16 a[204:205], v100 offset:4096
    v_alignbit_b32 v54, v38, v35, 16
    ds_read_b64_tr_b16 a[206:207], v100 offset:5120
    s_waitcnt lgkmcnt(3)
    s_nop 0
    v_mfma_f32_32x32x16_bf16 v[160:175], a[224:227], a[248:251], v[160:175]
    ds_read_b128 a[236:239], v117 offset:4096
    s_add_u32 m0, s79, 49152
    s_mul_i32 s82, s76, 229376
    s_add_u32 s82, s82, s40
    s_nop 0
    v_mfma_f32_32x32x16_bf16 v[224:239], a[224:227], a[252:255], v[224:239]
    buffer_load_dwordx4 v88, s[48:51], s82 offen offset:0  lds
    v_alignbit_b32 v55, v39, v38, 16
    ds_read_b64_tr_b16 a[208:209], v101 offset:4096
    v_mfma_f32_32x32x16_bf16 v[176:191], a[228:231], a[248:251], v[176:191]
    v_mov_b32_e64 v39, v38
    ds_read_b64_tr_b16 a[210:211], v101 offset:5120
    buffer_load_dwordx4 v89, s[48:51], s82 offen offset:1024  lds
    v_mfma_f32_32x32x16_bf16 v[240:255], a[228:231], a[252:255], v[240:255]
    v_mov_b32_e64 v38, v35
    ds_read_b64_tr_b16 a[212:213], v102 offset:4096
    ds_read_b64_tr_b16 a[214:215], v102 offset:5120
    v_mov_b32 v37, v34
    s_waitcnt lgkmcnt(4)
    v_mfma_f32_32x32x16_bf16 v[128:143], a[204:207], a[232:235], v[128:143]
    ds_read_b64_tr_b16 a[216:217], v103 offset:4096
    buffer_load_dwordx4 v90, s[48:51], s82 offen offset:2048  lds
    v_mfma_f32_32x32x16_bf16 v[192:207], a[204:207], a[236:239], v[192:207]
    v_mov_b32_e64 v36, v33
    ds_read_b64_tr_b16 a[218:219], v103 offset:5120
    s_waitcnt vmcnt(22)
    v_alignbit_b32 v56, v41, v40, 16
    ds_read_b128 a[240:243], v118 offset:0
    s_waitcnt lgkmcnt(3)
    v_mfma_f32_32x32x16_bf16 v[144:159], a[208:211], a[232:235], v[144:159]
    ds_read_b64_tr_b16 a[220:221], v100 offset:8192
    buffer_load_dwordx4 v91, s[48:51], s82 offen offset:3072  lds
    v_mfma_f32_32x32x16_bf16 v[208:223], a[208:211], a[236:239], v[208:223]
    v_alignbit_b32 v57, v42, v41, 16
    ds_read_b64_tr_b16 a[222:223], v100 offset:9216
    v_alignbit_b32 v58, v43, v42, 16
    ds_read_b128 a[244:247], v118 offset:4096
    v_mfma_f32_32x32x16_bf16 v[160:175], a[212:215], a[232:235], v[160:175]
    s_add_u32 m0, s79, 57344
    s_add_u32 s82, s82, s41
    buffer_load_dwordx4 v88, s[48:51], s82 offen offset:0  lds
    v_mfma_f32_32x32x16_bf16 v[224:239], a[212:215], a[236:239], v[224:239]
    s_waitcnt vmcnt(23)
    v_alignbit_b32 v59, v46, v43, 16
    ds_read_b64_tr_b16 a[224:225], v101 offset:8192
    ds_read_b64_tr_b16 a[226:227], v101 offset:9216
    v_alignbit_b32 v60, v42, v41, 16
    s_waitcnt lgkmcnt(3)
    s_nop 0
    v_mfma_f32_32x32x16_bf16 v[176:191], a[216:219], a[232:235], v[176:191]
    ds_read_b64_tr_b16 a[228:229], v102 offset:8192
    buffer_load_dwordx4 v89, s[48:51], s82 offen offset:1024  lds
    v_mfma_f32_32x32x16_bf16 v[240:255], a[216:219], a[236:239], v[240:255]
    v_alignbit_b32 v61, v43, v42, 16
    ds_read_b64_tr_b16 a[230:231], v102 offset:9216
    v_alignbit_b32 v62, v46, v43, 16
    ds_read_b64_tr_b16 a[204:205], v103 offset:8192
    v_mfma_f32_32x32x16_bf16 v[128:143], a[220:223], a[240:243], v[128:143]
    ds_read_b64_tr_b16 a[206:207], v103 offset:9216
    buffer_load_dwordx4 v90, s[48:51], s82 offen offset:2048  lds
    s_waitcnt lgkmcnt(4)
    v_mfma_f32_32x32x16_bf16 v[192:207], a[220:223], a[244:247], v[192:207]
    v_alignbit_b32 v63, v47, v46, 16
    ds_read_b128 a[248:251], v119 offset:0
    v_mov_b32 v47, v46
    v_mfma_f32_32x32x16_bf16 v[144:159], a[224:227], a[240:243], v[144:159]
    ds_read_b64_tr_b16 a[208:209], v100 offset:12288
    buffer_load_dwordx4 v91, s[48:51], s82 offen offset:3072  lds
    v_mfma_f32_32x32x16_bf16 v[208:223], a[224:227], a[244:247], v[208:223]
    v_mov_b32_e64 v46, v43
    ds_read_b64_tr_b16 a[210:211], v100 offset:13312
    ds_read_b128 a[252:255], v119 offset:4096
    s_waitcnt lgkmcnt(4)
    v_mfma_f32_32x32x16_bf16 v[160:175], a[228:231], a[240:243], v[160:175]
    v_mov_b32 v45, v42
    ds_read_b64_tr_b16 a[212:213], v101 offset:12288
    v_mov_b32_e64 v44, v41
    v_mfma_f32_32x32x16_bf16 v[224:239], a[228:231], a[244:247], v[224:239]
    ds_read_b64_tr_b16 a[214:215], v101 offset:13312
    v_mov_b32_e64 v12, 0
    v_mfma_f32_32x32x16_bf16 v[176:191], a[204:207], a[240:243], v[176:191]
    ds_read_b64_tr_b16 a[216:217], v102 offset:12288
    ds_read_b64_tr_b16 a[218:219], v102 offset:13312
    v_mov_b32_e64 v13, 0
    v_mfma_f32_32x32x16_bf16 v[240:255], a[204:207], a[244:247], v[240:255]
    ds_read_b64_tr_b16 a[220:221], v103 offset:12288
    v_mov_b32 v14, 0
    s_waitcnt lgkmcnt(5)
    v_mfma_f32_32x32x16_bf16 v[128:143], a[208:211], a[248:251], v[128:143]
    ds_read_b64_tr_b16 a[222:223], v103 offset:13312
    v_mfma_f32_32x32x16_bf16 v[192:207], a[208:211], a[252:255], v[192:207]
    v_mov_b32 v15, 0
    s_waitcnt lgkmcnt(4)
    v_mfma_f32_32x32x16_bf16 v[144:159], a[212:215], a[248:251], v[144:159]
    v_mfma_f32_32x32x16_bf16 v[208:223], a[212:215], a[252:255], v[208:223]
    s_waitcnt vmcnt(13)
    v_cmp_ne_u32 vcc, s21, v21
    s_nop 0
    s_cbranch_vccnz L_sf_slow
L_sf_ok:
    s_waitcnt vmcnt(12)
    v_cmp_ne_u32 vcc, s21, v73
    s_nop 0
    s_cbranch_vccnz L_wf_slow
L_wf_ok:
    s_waitcnt lgkmcnt(0)
    s_barrier
    buffer_load_dwordx4 v[84:87], v122, s[64:67], s42 offen offset:0 sc1
    ds_read_b128 a[232:235], v112 offset:0
    ds_read_b64_tr_b16 a[224:225], v96 offset:0
    v_mfma_f32_32x32x16_bf16 v[160:175], a[216:219], a[248:251], v[160:175]
    buffer_load_dwordx4 v[88:91], v122, s[64:67], s42 offen offset:1024 sc1
    ds_read_b64_tr_b16 a[226:227], v96 offset:1024
    v_mfma_f32_32x32x16_bf16 v[224:239], a[216:219], a[252:255], v[224:239]
    buffer_load_dwordx4 v[104:107], v122, s[64:67], s42 offen offset:2048 sc1
    ds_read_b128 a[236:239], v112 offset:4096
    ds_write_b128 v94, v[12:15] offset:20736
    v_mfma_f32_32x32x16_bf16 v[176:191], a[220:223], a[248:251], v[176:191]
    buffer_load_dwordx4 v[108:111], v122, s[64:67], s42 offen offset:3072 sc1
    ds_read_b64_tr_b16 a[228:229], v97 offset:0
    ds_read_b64_tr_b16 a[230:231], v97 offset:1024
    v_mfma_f32_32x32x16_bf16 v[240:255], a[220:223], a[252:255], v[240:255]
    buffer_load_dwordx2 v[26:27], v22, s[64:67], 0 offen sc1
    ds_read_b64_tr_b16 a[204:205], v98 offset:0
    s_waitcnt lgkmcnt(4)
    s_nop 0
    v_mfma_f32_32x32x16_bf16 v[128:143], a[224:227], a[232:235], v[128:143]
    ds_write_b16 v93, v66
    buffer_load_dwordx2 v[24:25], v22, s[64:67], 0 offen offset:256 sc1
    v_mfma_f32_32x32x16_bf16 v[192:207], a[224:227], a[236:239], v[192:207]
    ds_read_b64_tr_b16 a[206:207], v98 offset:1024
    ds_read_b64_tr_b16 a[208:209], v99 offset:0
    ds_read_b64_tr_b16 a[210:211], v99 offset:1024
    ds_read_b128 a[240:243], v113 offset:0
    s_waitcnt lgkmcnt(3)
    s_nop 0
    v_mfma_f32_32x32x16_bf16 v[144:159], a[228:231], a[232:235], v[144:159]
    buffer_load_dwordx4 a[0:3], v122, s[64:67], s93 offen offset:0 sc1
    ds_write_b128 v92, v[32:35] offset:32
    v_mfma_f32_32x32x16_bf16 v[208:223], a[228:231], a[236:239], v[208:223]
    ds_read_b64_tr_b16 a[212:213], v96 offset:4096
    buffer_load_dwordx4 a[4:7], v122, s[64:67], s93 offen offset:1024 sc1
    v_mfma_f32_32x32x16_bf16 v[160:175], a[204:207], a[232:235], v[160:175]
    ds_read_b64_tr_b16 a[214:215], v96 offset:5120
    ds_read_b128 a[244:247], v113 offset:4096
    ds_read_b64_tr_b16 a[216:217], v97 offset:4096
    v_mfma_f32_32x32x16_bf16 v[224:239], a[204:207], a[236:239], v[224:239]
    buffer_load_dwordx4 a[8:11], v122, s[64:67], s93 offen offset:2048 sc1
    s_waitcnt lgkmcnt(6)
    s_nop 0
    v_mfma_f32_32x32x16_bf16 v[176:191], a[208:211], a[232:235], v[176:191]
    ds_write_b128 v92, v[36:39] offset:8352
    ds_read_b64_tr_b16 a[218:219], v97 offset:5120
    ds_read_b64_tr_b16 a[220:221], v98 offset:4096
    v_mfma_f32_32x32x16_bf16 v[240:255], a[208:211], a[236:239], v[240:255]
    ds_read_b64_tr_b16 a[222:223], v98 offset:5120
    buffer_load_dwordx4 a[12:15], v122, s[64:67], s93 offen offset:3072 sc1
    s_waitcnt lgkmcnt(5)
    s_nop 0
    v_mfma_f32_32x32x16_bf16 v[128:143], a[212:215], a[240:243], v[128:143]
    s_add_u32 s93, s93, 4096
    ds_write_b128 v92, v[48:51] offset:4192
    ds_read_b64_tr_b16 a[224:225], v99 offset:4096
    v_mfma_f32_32x32x16_bf16 v[192:207], a[212:215], a[244:247], v[192:207]
    ds_read_b64_tr_b16 a[226:227], v99 offset:5120
    buffer_load_dwordx4 a[16:19], v122, s[64:67], s93 offen offset:0 sc1
    s_waitcnt lgkmcnt(3)
    s_nop 0
    v_mfma_f32_32x32x16_bf16 v[144:159], a[216:219], a[240:243], v[144:159]
    ds_read_b128 a[248:251], v114 offset:0
    ds_read_b64_tr_b16 a[228:229], v96 offset:8192
    buffer_load_dwordx4 a[20:23], v122, s[64:67], s93 offen offset:1024 sc1
    v_mfma_f32_32x32x16_bf16 v[208:223], a[216:219], a[244:247], v[208:223]
    ds_write_b128 v92, v[52:55] offset:12512
    ds_read_b64_tr_b16 a[230:231], v96 offset:9216
    ds_read_b128 a[252:255], v114 offset:4096
    v_mfma_f32_32x32x16_bf16 v[160:175], a[220:223], a[240:243], v[160:175]
    buffer_load_dwordx4 a[24:27], v122, s[64:67], s93 offen offset:2048 sc1
    buffer_load_dword v127, v83, s[64:67], 0 offen sc1
    v_mfma_f32_32x32x16_bf16 v[224:239], a[220:223], a[244:247], v[224:239]
    ds_read_b64_tr_b16 a[204:205], v97 offset:8192
    ds_read_b64_tr_b16 a[206:207], v97 offset:9216
    ds_write_b128 v92, v[40:43] offset:1056
    s_waitcnt lgkmcnt(4)
    s_nop 0
    v_mfma_f32_32x32x16_bf16 v[176:191], a[224:227], a[240:243], v[176:191]
    ds_read_b64_tr_b16 a[208:209], v98 offset:8192
    buffer_load_dwordx4 a[28:31], v122, s[64:67], s93 offen offset:3072 sc1
    v_mfma_f32_32x32x16_bf16 v[240:255], a[224:227], a[244:247], v[240:255]
    s_add_u32 s93, s93, 4096
    ds_read_b64_tr_b16 a[210:211], v98 offset:9216
    ds_write_b128 v92, v[44:47] offset:9376
    v_mfma_f32_32x32x16_bf16 v[128:143], a[228:231], a[248:251], v[128:143]
    ds_read_b64_tr_b16 a[212:213], v99 offset:8192
    ds_read_b64_tr_b16 a[214:215], v99 offset:9216
    s_waitcnt lgkmcnt(6)
    s_nop 0
    v_mfma_f32_32x32x16_bf16 v[192:207], a[228:231], a[252:255], v[192:207]
    buffer_load_dwordx4 a[32:35], v122, s[64:67], s93 offen offset:0 sc1
    ds_read_b128 a[232:235], v115 offset:0
    v_mfma_f32_32x32x16_bf16 v[144:159], a[204:207], a[248:251], v[144:159]
    ds_read_b64_tr_b16 a[216:217], v96 offset:12288
    buffer_load_dwordx4 a[36:39], v122, s[64:67], s93 offen offset:1024 sc1
    v_mfma_f32_32x32x16_bf16 v[208:223], a[204:207], a[252:255], v[208:223]
    ds_write_b128 v92, v[56:59] offset:5216
    ds_read_b64_tr_b16 a[218:219], v96 offset:13312
    ds_read_b128 a[236:239], v115 offset:4096
    s_waitcnt lgkmcnt(5)
    s_nop 0
    v_mfma_f32_32x32x16_bf16 v[160:175], a[208:211], a[248:251], v[160:175]
    buffer_load_dwordx4 a[40:43], v122, s[64:67], s93 offen offset:2048 sc1
    ds_read_b64_tr_b16 a[220:221], v97 offset:12288
    v_mfma_f32_32x32x16_bf16 v[224:239], a[208:211], a[252:255], v[224:239]
    ds_read_b64_tr_b16 a[222:223], v97 offset:13312
    buffer_load_dwordx4 a[44:47], v122, s[64:67], s93 offen offset:3072 sc1
    s_add_u32 s93, s93, 4096
    v_mfma_f32_32x32x16_bf16 v[176:191], a[212:215], a[248:251], v[176:191]
    ds_write_b128 v92, v[60:63] offset:13536
    ds_read_b64_tr_b16 a[224:225], v98 offset:12288
    ds_read_b64_tr_b16 a[226:227], v98 offset:13312
    v_mfma_f32_32x32x16_bf16 v[240:255], a[212:215], a[252:255], v[240:255]
    ds_read_b64_tr_b16 a[228:229], v99 offset:12288
    buffer_load_dwordx4 a[48:51], v122, s[64:67], s93 offen offset:0 sc1
    s_waitcnt lgkmcnt(6)
    s_nop 0
    v_mfma_f32_32x32x16_bf16 v[128:143], a[216:219], a[232:235], v[128:143]
    ds_read_b64_tr_b16 a[230:231], v99 offset:13312
    v_mfma_f32_32x32x16_bf16 v[192:207], a[216:219], a[236:239], v[192:207]
    buffer_load_dwordx4 a[52:55], v122, s[64:67], s93 offen offset:1024 sc1
    s_waitcnt lgkmcnt(5)
    v_mfma_f32_32x32x16_bf16 v[144:159], a[220:223], a[232:235], v[144:159]
    v_mfma_f32_32x32x16_bf16 v[208:223], a[220:223], a[236:239], v[208:223]
    s_waitcnt vmcnt(21) lgkmcnt(0)
    s_barrier
    s_nop 0
    ds_read_b128 a[240:243], v112 offset:49152
    ds_read_b64_tr_b16 a[204:205], v96 offset:49152
    v_mfma_f32_32x32x16_bf16 v[160:175], a[224:227], a[232:235], v[160:175]
    ds_read_b64_tr_b16 a[206:207], v96 offset:50176
    ds_read_b128 a[244:247], v112 offset:53248
    v_mfma_f32_32x32x16_bf16 v[224:239], a[224:227], a[236:239], v[224:239]
    ds_read_b64_tr_b16 a[208:209], v97 offset:49152
    ds_read_b64_tr_b16 a[210:211], v97 offset:50176
    v_mfma_f32_32x32x16_bf16 v[176:191], a[228:231], a[232:235], v[176:191]
    buffer_load_dwordx4 a[56:59], v122, s[64:67], s93 offen offset:2048 sc1
    s_waitcnt vmcnt(20)
    v_add_f32 v84, v84, v88
    v_mfma_f32_32x32x16_bf16 v[240:255], a[228:231], a[236:239], v[240:255]
    s_waitcnt vmcnt(18)
    v_add_f32 v104, v104, v108
    ds_read_b64_tr_b16 a[212:213], v98 offset:49152
    v_add_f32_e64 v85, v85, v89
    ds_read_b64_tr_b16 a[214:215], v98 offset:50176
    s_waitcnt lgkmcnt(4)
    v_mfma_f32_32x32x16_bf16 v[128:143], a[204:207], a[240:243], v[128:143]
    buffer_load_dwordx4 a[60:63], v122, s[64:67], s93 offen offset:3072 sc1
    s_add_u32 s93, s93, 4096
    v_add_f32 v105, v105, v109
    v_mfma_f32_32x32x16_bf16 v[192:207], a[204:207], a[244:247], v[192:207]
    v_add_f32_e64 v86, v86, v90
    s_add_u32 s82, s44, 114688
    ds_read_b64_tr_b16 a[216:217], v99 offset:49152
    ds_read_b64_tr_b16 a[218:219], v99 offset:50176
    v_add_f32 v106, v106, v110
    s_waitcnt lgkmcnt(4)
    v_mfma_f32_32x32x16_bf16 v[144:159], a[208:211], a[240:243], v[144:159]
    ds_read_b128 a[248:251], v113 offset:49152
    buffer_load_dwordx4 a[64:67], v122, s[64:67], s93 offen offset:0 sc1
    v_mfma_f32_32x32x16_bf16 v[208:223], a[208:211], a[244:247], v[208:223]
    v_add_f32 v87, v87, v91
    v_add_f32 v107, v107, v111
    ds_read_b64_tr_b16 a[220:221], v96 offset:53248
    v_add_f32 v84, v84, v104
    s_waitcnt lgkmcnt(4)
    v_mfma_f32_32x32x16_bf16 v[160:175], a[212:215], a[240:243], v[160:175]
    ds_read_b64_tr_b16 a[222:223], v96 offset:54272
    ds_read_b128 a[252:255], v113 offset:53248
    buffer_load_dwordx4 a[68:71], v122, s[64:67], s93 offen offset:1024 sc1
    v_mfma_f32_32x32x16_bf16 v[224:239], a[212:215], a[244:247], v[224:239]
    v_add_f32 v85, v85, v105
    v_add_f32 v86, v86, v106
    ds_read_b64_tr_b16 a[224:225], v97 offset:53248
    v_add_f32 v87, v87, v107
    s_waitcnt lgkmcnt(5)
    v_mfma_f32_32x32x16_bf16 v[176:191], a[216:219], a[240:243], v[176:191]
    ds_read_b64_tr_b16 a[226:227], v97 offset:54272
    buffer_load_dwordx4 a[72:75], v122, s[64:67], s93 offen offset:2048 sc1
    v_mfma_f32_32x32x16_bf16 v[240:255], a[216:219], a[244:247], v[240:255]
    ds_write_b128 v16, v[84:87]
    ds_read_b64_tr_b16 a[228:229], v98 offset:53248
    ds_read_b64_tr_b16 a[230:231], v98 offset:54272
    v_cmp_gt_u32 s[74:75], 32, v1
    s_waitcnt lgkmcnt(5)
    s_nop 0
    v_mfma_f32_32x32x16_bf16 v[128:143], a[220:223], a[248:251], v[128:143]
    ds_read_b64_tr_b16 a[204:205], v99 offset:53248
    buffer_load_dwordx4 a[76:79], v122, s[64:67], s93 offen offset:3072 sc1
    s_add_u32 s93, s93, 4096
    v_mfma_f32_32x32x16_bf16 v[192:207], a[220:223], a[252:255], v[192:207]
    s_waitcnt vmcnt(22)
    v_sub_f32 v108, 0, v26
    ds_read_b64_tr_b16 a[206:207], v99 offset:54272
    v_rsq_f32 v26, v27
    s_waitcnt lgkmcnt(5)
    v_mfma_f32_32x32x16_bf16 v[144:159], a[224:227], a[248:251], v[144:159]
    s_waitcnt vmcnt(13)
    v_cmp_ne_u32 vcc, s21, v127
    s_nop 0
    s_cbranch_vccnz L_pf_slow
L_pf_ok:
    s_waitcnt lgkmcnt(4)
    s_barrier
    s_add_u32 s77, s96, 1048576
    buffer_load_dwordx4 a[192:195], v122, s[64:67], s77 offen sc1
    buffer_load_dwordx4 a[196:199], v122, s[64:67], s77 offen offset:1024 sc1
    s_add_u32 s31, s96, 3276800
    ds_read_b128 a[232:235], v114 offset:49152
    ds_read_b64_tr_b16 a[208:209], v96 offset:57344
    buffer_load_dwordx4 a[80:83], v122, s[64:67], s93 offen offset:0 sc1
    ds_read_b32 v28, v17 offset:0
    ds_read_b32 v29, v17 offset:1024
    v_cvt_pk_bf16_f32 v109, v108, v108
    v_mfma_f32_32x32x16_bf16 v[208:223], a[224:227], a[252:255], v[208:223]
    ds_read_b64_tr_b16 a[210:211], v96 offset:58368
    ds_read_b32 v30, v17 offset:2048
    ds_read_b32 v31, v17 offset:3072
    v_mov_b32 v110, 0
    s_waitcnt lgkmcnt(7)
    v_mfma_f32_32x32x16_bf16 v[160:175], a[228:231], a[248:251], v[160:175]
    ds_read_b128 a[236:239], v114 offset:53248
    buffer_load_dwordx4 a[84:87], v122, s[64:67], s93 offen offset:1024 sc1
    v_mfma_f32_32x32x16_bf16 v[224:239], a[228:231], a[252:255], v[224:239]
    v_lshlrev_b32_e64 v109, 16, v109
    ds_read_b64_tr_b16 a[212:213], v97 offset:57344
    ds_read_b64_tr_b16 a[214:215], v97 offset:58368
    v_mfma_f32_32x32x16_bf16 v[176:191], a[204:207], a[248:251], v[176:191]
    v_mul_f32 v26, 0xbfb8aa3b, v26
    ds_read_b64_tr_b16 a[216:217], v98 offset:57344
    v_sub_f32_e64 v109, v108, v109
    ds_read_b64_tr_b16 a[218:219], v98 offset:58368
    v_mfma_f32_32x32x16_bf16 v[240:255], a[204:207], a[252:255], v[240:255]
    buffer_load_dwordx4 a[88:91], v122, s[64:67], s93 offen offset:2048 sc1
    v_mov_b32 v111, 0
    s_waitcnt lgkmcnt(4)
    v_mfma_f32_32x32x16_bf16 v[128:143], a[208:211], a[232:235], v[128:143]
    ds_read_b64_tr_b16 a[220:221], v99 offset:57344
    ds_read_b64_tr_b16 a[222:223], v99 offset:58368
    v_add_f32 v28, v28, v29
    v_add_f32 v30, v30, v31
    v_cvt_pk_bf16_f32 v108, v108, v109
    v_mfma_f32_32x32x16_bf16 v[192:207], a[208:211], a[236:239], v[192:207]
    ds_read_b128 a[240:243], v115 offset:49152
    buffer_load_dwordx4 a[92:95], v122, s[64:67], s93 offen offset:3072 sc1
    s_add_u32 s93, s93, 4096
    s_waitcnt lgkmcnt(3)
    v_mfma_f32_32x32x16_bf16 v[144:159], a[212:215], a[232:235], v[144:159]
    v_add_f32 v28, v28, v30
    v_cndmask_b32 v108, 0, v108, s[74:75]
    ds_read_b64_tr_b16 a[224:225], v96 offset:61440
    v_cvt_pk_bf16_f32 v30, v28, v28
    v_mov_b32_e64 v109, v108
    v_mfma_f32_32x32x16_bf16 v[208:223], a[212:215], a[236:239], v[208:223]
    ds_read_b64_tr_b16 a[226:227], v96 offset:62464
    ds_read_b128 a[244:247], v115 offset:53248
    buffer_load_dwordx4 a[96:99], v122, s[64:67], s93 offen offset:0 sc1
    v_lshlrev_b32_e64 v29, 16, v30
    v_mfma_f32_32x32x16_bf16 v[160:175], a[216:219], a[232:235], v[160:175]
    v_sub_f32_e64 v104, 0, v24
    ds_read_b64_tr_b16 a[228:229], v97 offset:61440
    v_sub_f32 v29, v28, v29
    v_rsq_f32 v24, v25
    v_mfma_f32_32x32x16_bf16 v[224:239], a[216:219], a[236:239], v[224:239]
    ds_read_b64_tr_b16 a[230:231], v97 offset:62464
    buffer_load_dwordx4 a[100:103], v122, s[64:67], s93 offen offset:1024 sc1
    v_cvt_pk_bf16_f32 v31, v29, v29
    s_waitcnt lgkmcnt(3)
    s_nop 0
    v_mfma_f32_32x32x16_bf16 v[176:191], a[220:223], a[232:235], v[176:191]
    v_cvt_pk_bf16_f32 v105, v104, v104
    ds_read_b64_tr_b16 a[204:205], v98 offset:61440
    ds_read_b64_tr_b16 a[206:207], v98 offset:62464
    ds_write_b64 v19, v[30:31]
    v_mov_b32_e64 v106, 0
    v_mfma_f32_32x32x16_bf16 v[240:255], a[220:223], a[236:239], v[240:255]
    ds_read_b64_tr_b16 a[208:209], v99 offset:61440
    buffer_load_dwordx4 a[104:107], v122, s[64:67], s93 offen offset:2048 sc1
    v_mfma_f32_32x32x16_bf16 v[128:143], a[224:227], a[240:243], v[128:143]
    v_lshlrev_b32_e64 v105, 16, v105
    ds_read_b64_tr_b16 a[210:211], v99 offset:62464
    v_mul_f32 v24, 0xbfb8aa3b, v24
    s_waitcnt lgkmcnt(5)
    s_nop 0
    v_mfma_f32_32x32x16_bf16 v[192:207], a[224:227], a[244:247], v[192:207]
    buffer_load_dwordx4 a[108:111], v122, s[64:67], s93 offen offset:3072 sc1
    v_mfma_f32_32x32x16_bf16 v[144:159], a[228:231], a[240:243], v[144:159]
    s_add_u32 s93, s93, 4096
    v_sub_f32 v105, v104, v105
    v_mov_b32 v107, 0
    v_mfma_f32_32x32x16_bf16 v[208:223], a[228:231], a[244:247], v[208:223]
    s_waitcnt lgkmcnt(0)
    s_barrier
    buffer_load_dwordx4 a[112:115], v122, s[64:67], s93 offen offset:0 sc1
    v_cvt_pk_bf16_f32 v104, v104, v105
    ds_read_b64 a[160:161], v23 offset:0
    ds_read_b64 a[164:165], v23 offset:256
    v_mfma_f32_32x32x16_bf16 v[160:175], a[204:207], a[240:243], v[160:175]
    v_cndmask_b32 v104, 0, v104, s[74:75]
    ds_read_b64 a[168:169], v23 offset:512
    ds_read_b64 a[172:173], v23 offset:768
    v_mfma_f32_32x32x16_bf16 v[224:239], a[204:207], a[244:247], v[224:239]
    buffer_load_dwordx4 a[116:119], v122, s[64:67], s93 offen offset:1024 sc1
    v_mfma_f32_32x32x16_bf16 v[176:191], a[208:211], a[240:243], v[176:191]
    v_mov_b32_e64 v105, v104
    v_mfma_f32_32x32x16_bf16 v[240:255], a[208:211], a[244:247], v[240:255]
    s_waitcnt lgkmcnt(3)
    v_mfma_f32_32x32x16_bf16 v[128:143], a[160:163], v[108:111], v[128:143]
    s_waitcnt lgkmcnt(2)
    v_mfma_f32_32x32x16_bf16 v[144:159], a[164:167], v[108:111], v[144:159]
    s_waitcnt lgkmcnt(1)
    v_mfma_f32_32x32x16_bf16 v[160:175], a[168:171], v[108:111], v[160:175]
    s_waitcnt lgkmcnt(0)
    v_mfma_f32_32x32x16_bf16 v[176:191], a[172:175], v[108:111], v[176:191]
    v_mfma_f32_32x32x16_bf16 v[192:207], a[160:163], v[104:107], v[192:207]
    v_mfma_f32_32x32x16_bf16 v[208:223], a[164:167], v[104:107], v[208:223]
    v_mfma_f32_32x32x16_bf16 v[224:239], a[168:171], v[104:107], v[224:239]
    v_mfma_f32_32x32x16_bf16 v[240:255], a[172:175], v[104:107], v[240:255]
    s_nop 1
    s_nop 0
    v_pk_mul_f32 v[136:137], v[128:129], v[136:137]
    v_pk_mul_f32 v[138:139], v[130:131], v[138:139]
    v_pk_mul_f32 v[140:141], v[132:133], v[140:141]
    v_pk_mul_f32 v[142:143], v[134:135], v[142:143]
    v_pk_mul_f32 v[128:129], v[128:129], v[26:27] op_sel_hi:[1,0]
    v_pk_mul_f32 v[130:131], v[130:131], v[26:27] op_sel_hi:[1,0]
    v_pk_mul_f32 v[132:133], v[132:133], v[26:27] op_sel_hi:[1,0]
    v_pk_mul_f32 v[134:135], v[134:135], v[26:27] op_sel_hi:[1,0]
    v_exp_f32 v128, v128
    v_exp_f32 v129, v129
    v_exp_f32 v130, v130
    v_exp_f32 v131, v131
    v_exp_f32 v132, v132
    v_exp_f32 v133, v133
    v_exp_f32 v134, v134
    v_exp_f32 v135, v135
    v_pk_fma_f32 v[128:129], v[128:129], v[26:27], v[26:27] op_sel:[0,1,1] op_sel_hi:[1,1,1]
    v_pk_fma_f32 v[130:131], v[130:131], v[26:27], v[26:27] op_sel:[0,1,1] op_sel_hi:[1,1,1]
    v_pk_fma_f32 v[132:133], v[132:133], v[26:27], v[26:27] op_sel:[0,1,1] op_sel_hi:[1,1,1]
    v_pk_fma_f32 v[134:135], v[134:135], v[26:27], v[26:27] op_sel:[0,1,1] op_sel_hi:[1,1,1]
    v_rcp_f32 v128, v128
    v_rcp_f32 v129, v129
    v_rcp_f32 v130, v130
    v_rcp_f32 v131, v131
    v_rcp_f32 v132, v132
    v_rcp_f32 v133, v133
    v_rcp_f32 v134, v134
    v_rcp_f32 v135, v135
    v_pk_mul_f32 v[136:137], v[136:137], v[128:129]
    v_pk_mul_f32 v[138:139], v[138:139], v[130:131]
    v_pk_mul_f32 v[140:141], v[140:141], v[132:133]
    v_pk_mul_f32 v[142:143], v[142:143], v[134:135]
    v_cvt_pk_bf16_f32 v128, v136, v137
    v_cvt_pk_bf16_f32 v129, v138, v139
    v_cvt_pk_bf16_f32 v130, v140, v141
    v_cvt_pk_bf16_f32 v131, v142, v143
    v_pk_mul_f32 v[152:153], v[144:145], v[152:153]
    v_pk_mul_f32 v[154:155], v[146:147], v[154:155]
    v_pk_mul_f32 v[156:157], v[148:149], v[156:157]
    v_pk_mul_f32 v[158:159], v[150:151], v[158:159]
    buffer_store_dwordx4 v[128:131], v122, s[64:67], s44 offen offset:0 sc1
    v_pk_mul_f32 v[144:145], v[144:145], v[26:27] op_sel_hi:[1,0]
    v_pk_mul_f32 v[146:147], v[146:147], v[26:27] op_sel_hi:[1,0]
    v_pk_mul_f32 v[148:149], v[148:149], v[26:27] op_sel_hi:[1,0]
    v_pk_mul_f32 v[150:151], v[150:151], v[26:27] op_sel_hi:[1,0]
    v_exp_f32 v144, v144
    v_exp_f32 v145, v145
    v_exp_f32 v146, v146
    v_exp_f32 v147, v147
    v_exp_f32 v148, v148
    v_exp_f32 v149, v149
    v_exp_f32 v150, v150
    v_exp_f32 v151, v151
    v_pk_fma_f32 v[144:145], v[144:145], v[26:27], v[26:27] op_sel:[0,1,1] op_sel_hi:[1,1,1]
    v_pk_fma_f32 v[146:147], v[146:147], v[26:27], v[26:27] op_sel:[0,1,1] op_sel_hi:[1,1,1]
    v_pk_fma_f32 v[148:149], v[148:149], v[26:27], v[26:27] op_sel:[0,1,1] op_sel_hi:[1,1,1]
    v_pk_fma_f32 v[150:151], v[150:151], v[26:27], v[26:27] op_sel:[0,1,1] op_sel_hi:[1,1,1]
    v_rcp_f32 v144, v144
    v_rcp_f32 v145, v145
    v_rcp_f32 v146, v146
    v_rcp_f32 v147, v147
    v_rcp_f32 v148, v148
    v_rcp_f32 v149, v149
    v_rcp_f32 v150, v150
    v_rcp_f32 v151, v151
    v_pk_mul_f32 v[152:153], v[152:153], v[144:145]
    v_pk_mul_f32 v[154:155], v[154:155], v[146:147]
    v_pk_mul_f32 v[156:157], v[156:157], v[148:149]
    v_pk_mul_f32 v[158:159], v[158:159], v[150:151]
    v_cvt_pk_bf16_f32 v144, v152, v153
    v_cvt_pk_bf16_f32 v145, v154, v155
    v_cvt_pk_bf16_f32 v146, v156, v157
    v_cvt_pk_bf16_f32 v147, v158, v159
    v_pk_mul_f32 v[168:169], v[160:161], v[168:169]
    v_pk_mul_f32 v[170:171], v[162:163], v[170:171]
    v_pk_mul_f32 v[172:173], v[164:165], v[172:173]
    v_pk_mul_f32 v[174:175], v[166:167], v[174:175]
    buffer_store_dwordx4 v[144:147], v122, s[64:67], s44 offen offset:1024 sc1
    v_pk_mul_f32 v[160:161], v[160:161], v[26:27] op_sel_hi:[1,0]
    v_pk_mul_f32 v[162:163], v[162:163], v[26:27] op_sel_hi:[1,0]
    v_pk_mul_f32 v[164:165], v[164:165], v[26:27] op_sel_hi:[1,0]
    v_pk_mul_f32 v[166:167], v[166:167], v[26:27] op_sel_hi:[1,0]
    v_exp_f32 v160, v160
    s_waitcnt vmcnt(13)
    ds_write_b128 v92, a[192:195] offset:16640
    v_exp_f32 v161, v161
    v_exp_f32 v162, v162
    v_exp_f32 v163, v163
    v_exp_f32 v164, v164
    v_exp_f32 v165, v165
    v_exp_f32 v166, v166
    v_exp_f32_e64 v167, v167
    v_pk_fma_f32 v[160:161], v[160:161], v[26:27], v[26:27] op_sel:[0,1,1] op_sel_hi:[1,1,1]
    v_pk_fma_f32 v[162:163], v[162:163], v[26:27], v[26:27] op_sel:[0,1,1] op_sel_hi:[1,1,1]
    v_pk_fma_f32 v[164:165], v[164:165], v[26:27], v[26:27] op_sel:[0,1,1] op_sel_hi:[1,1,1]
    v_pk_fma_f32 v[166:167], v[166:167], v[26:27], v[26:27] op_sel:[0,1,1] op_sel_hi:[1,1,1]
    s_waitcnt vmcnt(12)
    ds_write_b128 v92, a[196:199] offset:17664
    v_rcp_f32 v160, v160
    v_rcp_f32 v161, v161
    v_rcp_f32 v162, v162
    v_rcp_f32 v163, v163
    v_rcp_f32 v164, v164
    v_rcp_f32 v165, v165
    v_rcp_f32 v166, v166
    v_rcp_f32_e64 v167, v167
    v_pk_mul_f32 v[168:169], v[168:169], v[160:161]
    v_pk_mul_f32 v[170:171], v[170:171], v[162:163]
    v_pk_mul_f32 v[172:173], v[172:173], v[164:165]
    v_pk_mul_f32 v[174:175], v[174:175], v[166:167]
    v_cvt_pk_bf16_f32 v160, v168, v169
    v_cvt_pk_bf16_f32 v161, v170, v171
    v_cvt_pk_bf16_f32 v162, v172, v173
    v_cvt_pk_bf16_f32 v163, v174, v175
    v_pk_mul_f32 v[184:185], v[176:177], v[184:185]
    v_pk_mul_f32 v[186:187], v[178:179], v[186:187]
    v_pk_mul_f32 v[188:189], v[180:181], v[188:189]
    v_pk_mul_f32 v[190:191], v[182:183], v[190:191]
    buffer_store_dwordx4 v[160:163], v122, s[64:67], s44 offen offset:2048 sc1
    v_pk_mul_f32 v[176:177], v[176:177], v[26:27] op_sel_hi:[1,0]
    v_pk_mul_f32 v[178:179], v[178:179], v[26:27] op_sel_hi:[1,0]
    v_pk_mul_f32 v[180:181], v[180:181], v[26:27] op_sel_hi:[1,0]
    v_pk_mul_f32 v[182:183], v[182:183], v[26:27] op_sel_hi:[1,0]
    v_exp_f32 v176, v176
    v_exp_f32 v177, v177
    v_exp_f32 v178, v178
    v_exp_f32 v179, v179
    v_exp_f32 v180, v180
    v_exp_f32 v181, v181
    v_exp_f32 v182, v182
    v_exp_f32 v183, v183
    v_pk_fma_f32 v[176:177], v[176:177], v[26:27], v[26:27] op_sel:[0,1,1] op_sel_hi:[1,1,1]
    v_pk_fma_f32 v[178:179], v[178:179], v[26:27], v[26:27] op_sel:[0,1,1] op_sel_hi:[1,1,1]
    v_pk_fma_f32 v[180:181], v[180:181], v[26:27], v[26:27] op_sel:[0,1,1] op_sel_hi:[1,1,1]
    v_pk_fma_f32 v[182:183], v[182:183], v[26:27], v[26:27] op_sel:[0,1,1] op_sel_hi:[1,1,1]
    v_rcp_f32 v176, v176
    v_rcp_f32 v177, v177
    v_rcp_f32 v178, v178
    v_rcp_f32 v179, v179
    v_rcp_f32 v180, v180
    v_rcp_f32 v181, v181
    v_rcp_f32 v182, v182
    v_rcp_f32 v183, v183
    v_pk_mul_f32 v[184:185], v[184:185], v[176:177]
    v_pk_mul_f32 v[186:187], v[186:187], v[178:179]
    v_pk_mul_f32 v[188:189], v[188:189], v[180:181]
    v_pk_mul_f32 v[190:191], v[190:191], v[182:183]
    v_cvt_pk_bf16_f32 v176, v184, v185
    v_cvt_pk_bf16_f32 v177, v186, v187
    v_cvt_pk_bf16_f32 v178, v188, v189
    v_cvt_pk_bf16_f32 v179, v190, v191
    v_pk_mul_f32 v[200:201], v[192:193], v[200:201]
    v_pk_mul_f32 v[202:203], v[194:195], v[202:203]
    v_pk_mul_f32 v[204:205], v[196:197], v[204:205]
    v_pk_mul_f32 v[206:207], v[198:199], v[206:207]
    buffer_store_dwordx4 v[176:179], v122, s[64:67], s44 offen offset:3072 sc1
    v_pk_mul_f32 v[192:193], v[192:193], v[24:25] op_sel_hi:[1,0]
    v_pk_mul_f32 v[194:195], v[194:195], v[24:25] op_sel_hi:[1,0]
    v_pk_mul_f32 v[196:197], v[196:197], v[24:25] op_sel_hi:[1,0]
    v_pk_mul_f32 v[198:199], v[198:199], v[24:25] op_sel_hi:[1,0]
    v_exp_f32 v192, v192
    v_exp_f32 v193, v193
    v_exp_f32 v194, v194
    v_exp_f32 v195, v195
    v_exp_f32 v196, v196
    v_exp_f32 v197, v197
    v_exp_f32 v198, v198
    v_exp_f32 v199, v199
    v_pk_fma_f32 v[192:193], v[192:193], v[24:25], v[24:25] op_sel:[0,1,1] op_sel_hi:[1,1,1]
    v_pk_fma_f32 v[194:195], v[194:195], v[24:25], v[24:25] op_sel:[0,1,1] op_sel_hi:[1,1,1]
    v_pk_fma_f32 v[196:197], v[196:197], v[24:25], v[24:25] op_sel:[0,1,1] op_sel_hi:[1,1,1]
    v_pk_fma_f32 v[198:199], v[198:199], v[24:25], v[24:25] op_sel:[0,1,1] op_sel_hi:[1,1,1]
    v_rcp_f32 v192, v192
    v_rcp_f32 v193, v193
    v_rcp_f32 v194, v194
    v_rcp_f32 v195, v195
    v_rcp_f32 v196, v196
    v_rcp_f32 v197, v197
    v_rcp_f32 v198, v198
    v_rcp_f32 v199, v199
    v_pk_mul_f32 v[200:201], v[200:201], v[192:193]
    v_pk_mul_f32 v[202:203], v[202:203], v[194:195]
    v_pk_mul_f32 v[204:205], v[204:205], v[196:197]
    v_pk_mul_f32 v[206:207], v[206:207], v[198:199]
    v_cvt_pk_bf16_f32 v192, v200, v201
    v_cvt_pk_bf16_f32 v193, v202, v203
    v_cvt_pk_bf16_f32 v194, v204, v205
    v_cvt_pk_bf16_f32 v195, v206, v207
    v_pk_mul_f32 v[216:217], v[208:209], v[216:217]
    v_pk_mul_f32 v[218:219], v[210:211], v[218:219]
    v_pk_mul_f32 v[220:221], v[212:213], v[220:221]
    v_pk_mul_f32 v[222:223], v[214:215], v[222:223]
    buffer_store_dwordx4 v[192:195], v122, s[64:67], s82 offen offset:0 sc1
    v_pk_mul_f32 v[208:209], v[208:209], v[24:25] op_sel_hi:[1,0]
    v_pk_mul_f32 v[210:211], v[210:211], v[24:25] op_sel_hi:[1,0]
    v_pk_mul_f32 v[212:213], v[212:213], v[24:25] op_sel_hi:[1,0]
    v_pk_mul_f32 v[214:215], v[214:215], v[24:25] op_sel_hi:[1,0]
    v_exp_f32 v208, v208
    v_exp_f32 v209, v209
    v_exp_f32 v210, v210
    v_exp_f32 v211, v211
    v_exp_f32 v212, v212
    v_exp_f32 v213, v213
    v_exp_f32 v214, v214
    v_exp_f32 v215, v215
    v_pk_fma_f32 v[208:209], v[208:209], v[24:25], v[24:25] op_sel:[0,1,1] op_sel_hi:[1,1,1]
    v_pk_fma_f32 v[210:211], v[210:211], v[24:25], v[24:25] op_sel:[0,1,1] op_sel_hi:[1,1,1]
    v_pk_fma_f32 v[212:213], v[212:213], v[24:25], v[24:25] op_sel:[0,1,1] op_sel_hi:[1,1,1]
    v_pk_fma_f32 v[214:215], v[214:215], v[24:25], v[24:25] op_sel:[0,1,1] op_sel_hi:[1,1,1]
    v_rcp_f32 v208, v208
    v_rcp_f32 v209, v209
    v_rcp_f32 v210, v210
    v_rcp_f32 v211, v211
    v_rcp_f32 v212, v212
    v_rcp_f32 v213, v213
    v_rcp_f32 v214, v214
    v_rcp_f32 v215, v215
    v_pk_mul_f32 v[216:217], v[216:217], v[208:209]
    v_pk_mul_f32 v[218:219], v[218:219], v[210:211]
    v_pk_mul_f32 v[220:221], v[220:221], v[212:213]
    v_pk_mul_f32 v[222:223], v[222:223], v[214:215]
    v_cvt_pk_bf16_f32 v208, v216, v217
    v_cvt_pk_bf16_f32 v209, v218, v219
    v_cvt_pk_bf16_f32 v210, v220, v221
    v_cvt_pk_bf16_f32 v211, v222, v223
    v_pk_mul_f32 v[232:233], v[224:225], v[232:233]
    v_pk_mul_f32 v[234:235], v[226:227], v[234:235]
    v_pk_mul_f32 v[236:237], v[228:229], v[236:237]
    v_pk_mul_f32 v[238:239], v[230:231], v[238:239]
    buffer_store_dwordx4 v[208:211], v122, s[64:67], s82 offen offset:1024 sc1
    v_pk_mul_f32 v[224:225], v[224:225], v[24:25] op_sel_hi:[1,0]
    v_pk_mul_f32 v[226:227], v[226:227], v[24:25] op_sel_hi:[1,0]
    v_pk_mul_f32 v[228:229], v[228:229], v[24:25] op_sel_hi:[1,0]
    v_pk_mul_f32 v[230:231], v[230:231], v[24:25] op_sel_hi:[1,0]
    v_exp_f32 v224, v224
    v_exp_f32 v225, v225
    v_exp_f32 v226, v226
    v_exp_f32 v227, v227
    v_exp_f32 v228, v228
    v_exp_f32 v229, v229
    v_exp_f32 v230, v230
    v_exp_f32 v231, v231
    v_pk_fma_f32 v[224:225], v[224:225], v[24:25], v[24:25] op_sel:[0,1,1] op_sel_hi:[1,1,1]
    v_pk_fma_f32 v[226:227], v[226:227], v[24:25], v[24:25] op_sel:[0,1,1] op_sel_hi:[1,1,1]
    v_pk_fma_f32 v[228:229], v[228:229], v[24:25], v[24:25] op_sel:[0,1,1] op_sel_hi:[1,1,1]
    v_pk_fma_f32 v[230:231], v[230:231], v[24:25], v[24:25] op_sel:[0,1,1] op_sel_hi:[1,1,1]
    v_rcp_f32 v224, v224
    v_rcp_f32 v225, v225
    v_rcp_f32 v226, v226
    v_rcp_f32 v227, v227
    v_rcp_f32 v228, v228
    v_rcp_f32 v229, v229
    v_rcp_f32 v230, v230
    v_rcp_f32 v231, v231
    v_pk_mul_f32 v[232:233], v[232:233], v[224:225]
    v_pk_mul_f32 v[234:235], v[234:235], v[226:227]
    v_pk_mul_f32 v[236:237], v[236:237], v[228:229]
    v_pk_mul_f32 v[238:239], v[238:239], v[230:231]
    v_cvt_pk_bf16_f32 v224, v232, v233
    v_cvt_pk_bf16_f32 v225, v234, v235
    v_cvt_pk_bf16_f32 v226, v236, v237
    v_cvt_pk_bf16_f32 v227, v238, v239
    v_pk_mul_f32 v[248:249], v[240:241], v[248:249]
    v_pk_mul_f32 v[250:251], v[242:243], v[250:251]
    v_pk_mul_f32 v[252:253], v[244:245], v[252:253]
    v_pk_mul_f32 v[254:255], v[246:247], v[254:255]
    buffer_store_dwordx4 v[224:227], v122, s[64:67], s82 offen offset:2048 sc1
    v_pk_mul_f32 v[240:241], v[240:241], v[24:25] op_sel_hi:[1,0]
    v_pk_mul_f32 v[242:243], v[242:243], v[24:25] op_sel_hi:[1,0]
    v_pk_mul_f32 v[244:245], v[244:245], v[24:25] op_sel_hi:[1,0]
    v_pk_mul_f32 v[246:247], v[246:247], v[24:25] op_sel_hi:[1,0]
    v_exp_f32 v240, v240
    v_exp_f32 v241, v241
    v_exp_f32 v242, v242
    v_exp_f32 v243, v243
    v_exp_f32 v244, v244
    v_exp_f32 v245, v245
    v_exp_f32 v246, v246
    s_waitcnt lgkmcnt(0)
    s_barrier
    v_exp_f32 v247, v247
    v_pk_fma_f32 v[240:241], v[240:241], v[24:25], v[24:25] op_sel:[0,1,1] op_sel_hi:[1,1,1]
    ds_read_b128 v[160:163], v71 offset:3584
    v_pk_fma_f32 v[242:243], v[242:243], v[24:25], v[24:25] op_sel:[0,1,1] op_sel_hi:[1,1,1]
    ds_read_b64 v[128:129], v70 offset:0
    v_pk_fma_f32 v[244:245], v[244:245], v[24:25], v[24:25] op_sel:[0,1,1] op_sel_hi:[1,1,1]
    v_pk_fma_f32 v[246:247], v[246:247], v[24:25], v[24:25] op_sel:[0,1,1] op_sel_hi:[1,1,1]
    ds_read_b64 v[130:131], v70 offset:8
    v_rcp_f32_e64 v240, v240
    ds_read_b128 v[164:167], v71 offset:3072
    v_rcp_f32 v241, v241
    v_rcp_f32 v242, v242
    ds_read_b64 v[132:133], v70 offset:512
    v_rcp_f32_e64 v243, v243
    ds_read_b64 v[134:135], v70 offset:520
    v_rcp_f32 v244, v244
    v_rcp_f32 v245, v245
    ds_read_b128 v[168:171], v71 offset:2560
    v_rcp_f32_e64 v246, v246
    ds_read_b64 v[136:137], v70 offset:1024
    v_rcp_f32_e64 v247, v247
    v_pk_mul_f32 v[248:249], v[248:249], v[240:241]
    ds_read_b64 v[138:139], v70 offset:1032
    v_pk_mul_f32 v[250:251], v[250:251], v[242:243]
    ds_read_b128 v[172:175], v71 offset:2048
    v_pk_mul_f32 v[252:253], v[252:253], v[244:245]
    v_pk_mul_f32 v[254:255], v[254:255], v[246:247]
    ds_read_b64 v[140:141], v70 offset:1536
    v_cvt_pk_bf16_f32 v240, v248, v249
    ds_read_b64 v[142:143], v70 offset:1544
    v_cvt_pk_bf16_f32 v241, v250, v251
    v_cvt_pk_bf16_f32 v242, v252, v253
    s_waitcnt vmcnt(3)
    v_mov_b32 v10, s84
    v_mov_b32 v11, s6
    s_mov_b64 exec, 1
    buffer_store_dword v11, v10, s[64:67], 0 offen sc1
    s_mov_b64 exec, -1
    v_cvt_pk_bf16_f32 v243, v254, v255
    buffer_store_dwordx4 v[240:243], v122, s[64:67], s82 offen offset:3072 sc1
L_tail:
    s_waitcnt lgkmcnt(8)
    v_mfma_f32_16x16x32_bf16 v[32:35], v[128:131], v[160:163], 0
    ds_read_b128 v[176:179], v71 offset:1536
    v_mfma_f32_16x16x32_bf16 v[36:39], v[128:131], v[164:167], 0
    ds_read_b64 v[144:145], v70 offset:2048
    s_waitcnt lgkmcnt(7)
    s_nop 0
    v_mfma_f32_16x16x32_bf16 v[36:39], v[132:135], v[160:163], v[36:39]
    ds_read_b64 v[146:147], v70 offset:2056
    v_mfma_f32_16x16x32_bf16 v[40:43], v[128:131], v[168:171], 0
    ds_read_b128 v[180:183], v71 offset:1024
    v_mfma_f32_16x16x32_bf16 v[40:43], v[132:135], v[164:167], v[40:43]
    ds_read_b64 v[148:149], v70 offset:2560
    s_waitcnt lgkmcnt(7)
    s_nop 0
    v_mfma_f32_16x16x32_bf16 v[40:43], v[136:139], v[160:163], v[40:43]
    ds_read_b64 v[150:151], v70 offset:2568
    v_mfma_f32_16x16x32_bf16 v[44:47], v[128:131], v[172:175], 0
    ds_read_b128 v[184:187], v71 offset:512
    v_mfma_f32_16x16x32_bf16 v[44:47], v[132:135], v[168:171], v[44:47]
    ds_read_b64 v[152:153], v70 offset:3072
    v_mfma_f32_16x16x32_bf16 v[44:47], v[136:139], v[164:167], v[44:47]
    ds_read_b64 v[154:155], v70 offset:3080
    s_waitcnt lgkmcnt(8)
    s_nop 0
    v_mfma_f32_16x16x32_bf16 v[44:47], v[140:143], v[160:163], v[44:47]
    ds_read_b128 v[188:191], v71 offset:0
    ds_read_b64 v[156:157], v70 offset:3584
    v_mfma_f32_16x16x32_bf16 v[48:51], v[128:131], v[176:179], 0
    buffer_load_dwordx4 a[120:123], v122, s[64:67], s93 offen offset:2048 sc1
    v_mfma_f32_16x16x32_bf16 v[48:51], v[132:135], v[172:175], v[48:51]
    ds_read_b64 v[158:159], v70 offset:3592
    v_mfma_f32_16x16x32_bf16 v[48:51], v[136:139], v[168:171], v[48:51]
    v_mfma_f32_16x16x32_bf16 v[48:51], v[140:143], v[164:167], v[48:51]
    buffer_load_dwordx4 a[124:127], v122, s[64:67], s93 offen offset:3072 sc1
    s_waitcnt lgkmcnt(8)
    s_nop 0
    v_mfma_f32_16x16x32_bf16 v[48:51], v[144:147], v[160:163], v[48:51]
    s_add_u32 s93, s93, 4096
    ds_read_b128 v[224:227], v71 offset:3648
    v_mfma_f32_16x16x32_bf16 v[52:55], v[128:131], v[180:183], 0
    ds_read_b64 v[192:193], v70 offset:64
    v_mfma_f32_16x16x32_bf16 v[52:55], v[132:135], v[176:179], v[52:55]
    ds_read_b64 v[194:195], v70 offset:72
    v_mfma_f32_16x16x32_bf16 v[52:55], v[136:139], v[172:175], v[52:55]
    buffer_load_dwordx4 a[128:131], v122, s[64:67], s93 offen offset:0 sc1
    v_mfma_f32_16x16x32_bf16 v[52:55], v[140:143], v[168:171], v[52:55]
    ds_read_b128 v[228:231], v71 offset:3136
    v_mfma_f32_16x16x32_bf16 v[52:55], v[144:147], v[164:167], v[52:55]
    ds_read_b64 v[196:197], v70 offset:576
    s_waitcnt lgkmcnt(10)
    s_nop 0
    v_mfma_f32_16x16x32_bf16 v[52:55], v[148:151], v[160:163], v[52:55]
    buffer_load_dwordx4 a[132:135], v122, s[64:67], s93 offen offset:1024 sc1
    v_mfma_f32_16x16x32_bf16 v[56:59], v[128:131], v[184:187], 0
    ds_read_b64 v[198:199], v70 offset:584
    v_mfma_f32_16x16x32_bf16 v[56:59], v[132:135], v[180:183], v[56:59]
    v_mfma_f32_16x16x32_bf16 v[56:59], v[136:139], v[176:179], v[56:59]
    ds_read_b128 v[232:235], v71 offset:2624
    v_mfma_f32_16x16x32_bf16 v[56:59], v[140:143], v[172:175], v[56:59]
    ds_read_b64 v[200:201], v70 offset:1088
    v_mfma_f32_16x16x32_bf16 v[56:59], v[144:147], v[168:171], v[56:59]
    buffer_load_dwordx4 a[136:139], v122, s[64:67], s93 offen offset:2048 sc1
    v_mfma_f32_16x16x32_bf16 v[56:59], v[148:151], v[164:167], v[56:59]
    ds_read_b64 v[202:203], v70 offset:1096
    ds_read_b128 v[236:239], v71 offset:2112
    s_waitcnt lgkmcnt(12)
    s_nop 0
    v_mfma_f32_16x16x32_bf16 v[56:59], v[152:155], v[160:163], v[56:59]
    buffer_load_dwordx4 a[140:143], v122, s[64:67], s93 offen offset:3072 sc1
    v_mfma_f32_16x16x32_bf16 v[60:63], v[128:131], v[188:191], 0
    s_add_u32 s93, s93, 4096
    v_mfma_f32_16x16x32_bf16 v[60:63], v[132:135], v[184:187], v[60:63]
    ds_read_b64 v[204:205], v70 offset:1600
    v_mfma_f32_16x16x32_bf16 v[60:63], v[136:139], v[180:183], v[60:63]
    ds_read_b64 v[206:207], v70 offset:1608
    v_mfma_f32_16x16x32_bf16 v[60:63], v[140:143], v[176:179], v[60:63]
    buffer_load_dwordx4 a[144:147], v122, s[64:67], s93 offen offset:0 sc1
    v_mfma_f32_16x16x32_bf16 v[60:63], v[144:147], v[172:175], v[60:63]
    ds_read_b128 v[240:243], v71 offset:1600
    v_mfma_f32_16x16x32_bf16 v[60:63], v[148:151], v[168:171], v[60:63]
    ds_read_b64 v[208:209], v70 offset:2112
    v_mfma_f32_16x16x32_bf16 v[60:63], v[152:155], v[164:167], v[60:63]
    buffer_load_dwordx4 a[148:151], v122, s[64:67], s93 offen offset:1024 sc1
    s_waitcnt lgkmcnt(11)
    s_nop 0
    v_mfma_f32_16x16x32_bf16 v[60:63], v[156:159], v[160:163], v[60:63]
    ds_read_b64 v[210:211], v70 offset:2120
    v_mfma_f32_16x16x32_bf16 v[32:35], v[192:195], v[224:227], v[32:35]
    ds_read_b128 v[244:247], v71 offset:1088
    s_waitcnt lgkmcnt(10)
    s_nop 0
    v_mfma_f32_16x16x32_bf16 v[36:39], v[192:195], v[228:231], v[36:39]
    ds_read_b64 v[212:213], v70 offset:2624
    v_mfma_f32_16x16x32_bf16 v[36:39], v[196:199], v[224:227], v[36:39]
    buffer_load_dwordx4 a[152:155], v122, s[64:67], s93 offen offset:2048 sc1
    s_waitcnt lgkmcnt(8)
    s_nop 0
    v_mfma_f32_16x16x32_bf16 v[40:43], v[192:195], v[232:235], v[40:43]
    ds_read_b64 v[214:215], v70 offset:2632
    v_mfma_f32_16x16x32_bf16 v[40:43], v[196:199], v[228:231], v[40:43]
    ds_read_b128 v[248:251], v71 offset:576
    v_mfma_f32_16x16x32_bf16 v[40:43], v[200:203], v[224:227], v[40:43]
    buffer_load_dwordx4 a[156:159], v122, s[64:67], s93 offen offset:3072 sc1
    s_waitcnt lgkmcnt(7)
    s_nop 0
    v_mfma_f32_16x16x32_bf16 v[44:47], v[192:195], v[236:239], v[44:47]
    s_add_u32 s93, s93, 4096
    v_mfma_f32_16x16x32_bf16 v[44:47], v[196:199], v[232:235], v[44:47]
    ds_read_b64 v[216:217], v70 offset:3136
    v_mfma_f32_16x16x32_bf16 v[44:47], v[200:203], v[228:231], v[44:47]
    ds_read_b64 v[218:219], v70 offset:3144
    v_mfma_f32_16x16x32_bf16 v[44:47], v[204:207], v[224:227], v[44:47]
    ds_read_b128 v[252:255], v71 offset:64
    s_waitcnt lgkmcnt(7)
    s_nop 0
    v_mfma_f32_16x16x32_bf16 v[48:51], v[192:195], v[240:243], v[48:51]
    buffer_load_dwordx4 a[160:163], v122, s[64:67], s93 offen offset:0 sc1
    v_mfma_f32_16x16x32_bf16 v[48:51], v[196:199], v[236:239], v[48:51]
    ds_read_b64 v[220:221], v70 offset:3648
    v_mfma_f32_16x16x32_bf16 v[48:51], v[200:203], v[232:235], v[48:51]
    ds_read_b64 v[222:223], v70 offset:3656
    v_mfma_f32_16x16x32_bf16 v[48:51], v[204:207], v[228:231], v[48:51]
    buffer_load_dwordx4 a[164:167], v122, s[64:67], s93 offen offset:1024 sc1
    v_mfma_f32_16x16x32_bf16 v[48:51], v[208:211], v[224:227], v[48:51]
    ds_read_b128 v[160:163], v71 offset:3712
    s_waitcnt lgkmcnt(7)
    s_nop 0
    v_mfma_f32_16x16x32_bf16 v[52:55], v[192:195], v[244:247], v[52:55]
    ds_read_b64 v[128:129], v70 offset:128
    v_mfma_f32_16x16x32_bf16 v[52:55], v[196:199], v[240:243], v[52:55]
    buffer_load_dwordx4 a[168:171], v122, s[64:67], s93 offen offset:2048 sc1
    v_mfma_f32_16x16x32_bf16 v[52:55], v[200:203], v[236:239], v[52:55]
    ds_read_b64 v[130:131], v70 offset:136
    v_mfma_f32_16x16x32_bf16 v[52:55], v[204:207], v[232:235], v[52:55]
    ds_read_b128 v[164:167], v71 offset:3200
    v_mfma_f32_16x16x32_bf16 v[52:55], v[208:211], v[228:231], v[52:55]
    buffer_load_dwordx4 a[172:175], v122, s[64:67], s93 offen offset:3072 sc1
    v_mfma_f32_16x16x32_bf16 v[52:55], v[212:215], v[224:227], v[52:55]
    s_add_u32 s93, s93, 4096
    ds_read_b64 v[132:133], v70 offset:640
    s_waitcnt lgkmcnt(10)
    s_nop 0
    v_mfma_f32_16x16x32_bf16 v[56:59], v[192:195], v[248:251], v[56:59]
    ds_read_b64 v[134:135], v70 offset:648
    v_mfma_f32_16x16x32_bf16 v[56:59], v[196:199], v[244:247], v[56:59]
    ds_read_b128 v[168:171], v71 offset:2688
    v_mfma_f32_16x16x32_bf16 v[56:59], v[200:203], v[240:243], v[56:59]
    buffer_load_dwordx4 a[176:179], v122, s[64:67], s93 offen offset:0 sc1
    v_mfma_f32_16x16x32_bf16 v[56:59], v[204:207], v[236:239], v[56:59]
    ds_read_b64 v[136:137], v70 offset:1152
    s_waitcnt vmcnt(15)
    s_add_u32 s84, s84, 4096
    v_mov_b32 v10, s84
    v_mov_b32 v11, s6
    s_mov_b64 exec, 1
    buffer_store_dword v11, v10, s[64:67], 0 offen sc1
    s_mov_b64 exec, -1
    s_nop 0
    v_mfma_f32_16x16x32_bf16 v[56:59], v[208:211], v[232:235], v[56:59]
    ds_read_b64 v[138:139], v70 offset:1160
    v_mfma_f32_16x16x32_bf16 v[56:59], v[212:215], v[228:231], v[56:59]
    buffer_load_dwordx4 a[180:183], v122, s[64:67], s93 offen offset:1024 sc1
    s_waitcnt lgkmcnt(11)
    s_nop 0
    v_mfma_f32_16x16x32_bf16 v[56:59], v[216:219], v[224:227], v[56:59]
    ds_read_b128 v[172:175], v71 offset:2176
    v_mfma_f32_16x16x32_bf16 v[60:63], v[192:195], v[252:255], v[60:63]
    v_mfma_f32_16x16x32_bf16 v[60:63], v[196:199], v[248:251], v[60:63]
    ds_read_b64 v[140:141], v70 offset:1664
    v_mfma_f32_16x16x32_bf16 v[60:63], v[200:203], v[244:247], v[60:63]
    ds_read_b64 v[142:143], v70 offset:1672
    v_mfma_f32_16x16x32_bf16 v[60:63], v[204:207], v[240:243], v[60:63]
    buffer_load_dwordx4 a[184:187], v122, s[64:67], s93 offen offset:2048 sc1
    v_mfma_f32_16x16x32_bf16 v[60:63], v[208:211], v[236:239], v[60:63]
    ds_read_b128 v[176:179], v71 offset:1664
    ds_read_b64 v[144:145], v70 offset:2176
    v_mfma_f32_16x16x32_bf16 v[60:63], v[212:215], v[232:235], v[60:63]
    buffer_load_dwordx4 a[188:191], v122, s[64:67], s93 offen offset:3072 sc1
    v_mfma_f32_16x16x32_bf16 v[60:63], v[216:219], v[228:231], v[60:63]
    s_add_u32 s93, s93, 4096
    s_waitcnt lgkmcnt(11)
    s_nop 0
    v_mfma_f32_16x16x32_bf16 v[60:63], v[220:223], v[224:227], v[60:63]
    ds_read_b64 v[146:147], v70 offset:2184
    ds_read_b128 v[180:183], v71 offset:1152
    v_mfma_f32_16x16x32_bf16 v[32:35], v[128:131], v[160:163], v[32:35]
    buffer_load_dword v126, v82, s[64:67], 0 offen sc1
    s_waitcnt lgkmcnt(10)
    s_nop 0
    v_mfma_f32_16x16x32_bf16 v[36:39], v[128:131], v[164:167], v[36:39]
    buffer_load_dwordx4 a[192:195], v122, s[64:67], s93 offen offset:0 sc1
    v_mfma_f32_16x16x32_bf16 v[36:39], v[132:135], v[160:163], v[36:39]
    ds_read_b64 v[148:149], v70 offset:2688
    s_waitcnt lgkmcnt(8)
    s_nop 0
    v_mfma_f32_16x16x32_bf16 v[40:43], v[128:131], v[168:171], v[40:43]
    ds_read_b64 v[150:151], v70 offset:2696
    v_mfma_f32_16x16x32_bf16 v[40:43], v[132:135], v[164:167], v[40:43]
    buffer_load_dwordx4 a[196:199], v122, s[64:67], s93 offen offset:1024 sc1
    v_mfma_f32_16x16x32_bf16 v[40:43], v[136:139], v[160:163], v[40:43]
    ds_read_b128 v[184:187], v71 offset:640
    s_waitcnt lgkmcnt(7)
    s_nop 0
    v_mfma_f32_16x16x32_bf16 v[44:47], v[128:131], v[172:175], v[44:47]
    ds_read_b64 v[152:153], v70 offset:3200
    v_mfma_f32_16x16x32_bf16 v[44:47], v[132:135], v[168:171], v[44:47]
    ds_read_b64 v[154:155], v70 offset:3208
    v_mfma_f32_16x16x32_bf16 v[44:47], v[136:139], v[164:167], v[44:47]
    buffer_load_dwordx4 a[200:203], v122, s[64:67], s93 offen offset:2048 sc1
    v_mfma_f32_16x16x32_bf16 v[44:47], v[140:143], v[160:163], v[44:47]
    ds_read_b128 v[188:191], v71 offset:128
    s_waitcnt lgkmcnt(7)
    s_nop 0
    v_mfma_f32_16x16x32_bf16 v[48:51], v[128:131], v[176:179], v[48:51]
    ds_read_b64 v[156:157], v70 offset:3712
    v_mfma_f32_16x16x32_bf16 v[48:51], v[132:135], v[172:175], v[48:51]
    buffer_load_dwordx4 a[204:207], v122, s[64:67], s93 offen offset:3072 sc1
    v_mfma_f32_16x16x32_bf16 v[48:51], v[136:139], v[168:171], v[48:51]
    s_add_u32 s93, s93, 4096
    v_mfma_f32_16x16x32_bf16 v[48:51], v[140:143], v[164:167], v[48:51]
    ds_read_b64 v[158:159], v70 offset:3720
    v_mfma_f32_16x16x32_bf16 v[48:51], v[144:147], v[160:163], v[48:51]
    ds_read_b128 v[224:227], v71 offset:3776
    s_waitcnt lgkmcnt(7)
    s_nop 0
    v_mfma_f32_16x16x32_bf16 v[52:55], v[128:131], v[180:183], v[52:55]
    ds_read_b64 v[192:193], v70 offset:192
    v_mfma_f32_16x16x32_bf16 v[52:55], v[132:135], v[176:179], v[52:55]
    buffer_load_dwordx4 a[208:211], v122, s[64:67], s93 offen offset:0 sc1
    v_mfma_f32_16x16x32_bf16 v[52:55], v[136:139], v[172:175], v[52:55]
    ds_read_b64 v[194:195], v70 offset:200
    v_mfma_f32_16x16x32_bf16 v[52:55], v[140:143], v[168:171], v[52:55]
    ds_read_b128 v[228:231], v71 offset:3264
    v_mfma_f32_16x16x32_bf16 v[52:55], v[144:147], v[164:167], v[52:55]
    buffer_load_dwordx4 a[212:215], v122, s[64:67], s93 offen offset:1024 sc1
    v_mfma_f32_16x16x32_bf16 v[52:55], v[148:151], v[160:163], v[52:55]
    ds_read_b64 v[196:197], v70 offset:704
    s_waitcnt lgkmcnt(8)
    s_nop 0
    v_mfma_f32_16x16x32_bf16 v[56:59], v[128:131], v[184:187], v[56:59]
    ds_read_b64 v[198:199], v70 offset:712
    v_mfma_f32_16x16x32_bf16 v[56:59], v[132:135], v[180:183], v[56:59]
    buffer_load_dwordx4 a[216:219], v122, s[64:67], s93 offen offset:2048 sc1
    v_mfma_f32_16x16x32_bf16 v[56:59], v[136:139], v[176:179], v[56:59]
    ds_read_b128 v[232:235], v71 offset:2752
    v_mfma_f32_16x16x32_bf16 v[56:59], v[140:143], v[172:175], v[56:59]
    ds_read_b64 v[200:201], v70 offset:1216
    v_mfma_f32_16x16x32_bf16 v[56:59], v[144:147], v[168:171], v[56:59]
    buffer_load_dwordx4 a[220:223], v122, s[64:67], s93 offen offset:3072 sc1
    v_mfma_f32_16x16x32_bf16 v[56:59], v[148:151], v[164:167], v[56:59]
    s_add_u32 s93, s93, 4096
    ds_read_b64 v[202:203], v70 offset:1224
    v_mfma_f32_16x16x32_bf16 v[56:59], v[152:155], v[160:163], v[56:59]
    ds_read_b128 v[236:239], v71 offset:2240
    s_waitcnt lgkmcnt(10)
    s_nop 0
    v_mfma_f32_16x16x32_bf16 v[60:63], v[128:131], v[188:191], v[60:63]
    v_mfma_f32_16x16x32_bf16 v[60:63], v[132:135], v[184:187], v[60:63]
    ds_read_b64 v[204:205], v70 offset:1728
    v_mfma_f32_16x16x32_bf16 v[60:63], v[136:139], v[180:183], v[60:63]
    ds_read_b64 v[206:207], v70 offset:1736
    v_mfma_f32_16x16x32_bf16 v[60:63], v[140:143], v[176:179], v[60:63]
    v_mfma_f32_16x16x32_bf16 v[60:63], v[144:147], v[172:175], v[60:63]
    ds_read_b128 v[240:243], v71 offset:1728
    v_mfma_f32_16x16x32_bf16 v[60:63], v[148:151], v[168:171], v[60:63]
    ds_read_b64 v[208:209], v70 offset:2240
    v_mfma_f32_16x16x32_bf16 v[60:63], v[152:155], v[164:167], v[60:63]
    v_mfma_f32_16x16x32_bf16 v[60:63], v[156:159], v[160:163], v[60:63]
    ds_read_b64 v[210:211], v70 offset:2248
    s_waitcnt lgkmcnt(12)
    v_mfma_f32_16x16x32_bf16 v[32:35], v[192:195], v[224:227], v[32:35]
    ds_read_b128 v[244:247], v71 offset:1216
    s_waitcnt vmcnt(8)
    v_cmp_ne_u32 vcc, s21, v126
    s_nop 0
    s_cbranch_vccnz L_hf_slow
L_hf_ok:
    s_barrier
    s_waitcnt lgkmcnt(10)
    s_nop 0
    v_mfma_f32_16x16x32_bf16 v[36:39], v[192:195], v[228:231], v[36:39]
    buffer_load_dwordx4 v[128:131], v9, s[64:67], s86 offen offset:0 sc1
    v_mfma_f32_16x16x32_bf16 v[36:39], v[196:199], v[224:227], v[36:39]
    ds_read_b64 v[212:213], v70 offset:2752
    s_waitcnt lgkmcnt(8)
    s_nop 0
    v_mfma_f32_16x16x32_bf16 v[40:43], v[192:195], v[232:235], v[40:43]
    ds_read_b64 v[214:215], v70 offset:2760
    v_mfma_f32_16x16x32_bf16 v[40:43], v[196:199], v[228:231], v[40:43]
    buffer_load_dwordx4 v[132:135], v9, s[64:67], s86 offen offset:2048 sc1
    v_mfma_f32_16x16x32_bf16 v[40:43], v[200:203], v[224:227], v[40:43]
    ds_read_b128 v[248:251], v71 offset:704
    s_waitcnt lgkmcnt(7)
    s_nop 0
    v_mfma_f32_16x16x32_bf16 v[44:47], v[192:195], v[236:239], v[44:47]
    ds_read_b64 v[216:217], v70 offset:3264
    v_mfma_f32_16x16x32_bf16 v[44:47], v[196:199], v[232:235], v[44:47]
    ds_read_b64 v[218:219], v70 offset:3272
    v_mfma_f32_16x16x32_bf16 v[44:47], v[200:203], v[228:231], v[44:47]
    buffer_load_dwordx4 v[136:139], v9, s[64:67], s87 offen offset:0 sc1
    v_mfma_f32_16x16x32_bf16 v[44:47], v[204:207], v[224:227], v[44:47]
    ds_read_b128 v[252:255], v71 offset:192
    s_waitcnt lgkmcnt(7)
    s_nop 0
    v_mfma_f32_16x16x32_bf16 v[48:51], v[192:195], v[240:243], v[48:51]
    ds_read_b64 v[220:221], v70 offset:3776
    v_mfma_f32_16x16x32_bf16 v[48:51], v[196:199], v[236:239], v[48:51]
    buffer_load_dwordx4 v[140:143], v9, s[64:67], s87 offen offset:2048 sc1
    v_mfma_f32_16x16x32_bf16 v[48:51], v[200:203], v[232:235], v[48:51]
    ds_read_b64 v[222:223], v70 offset:3784
    v_mfma_f32_16x16x32_bf16 v[48:51], v[204:207], v[228:231], v[48:51]
    v_mfma_f32_16x16x32_bf16 v[48:51], v[208:211], v[224:227], v[48:51]
    s_waitcnt lgkmcnt(6)
    s_nop 0
    v_mfma_f32_16x16x32_bf16 v[52:55], v[192:195], v[244:247], v[52:55]
    buffer_load_dwordx4 v[144:147], v9, s[64:67], s88 offen offset:0 sc1
    v_mfma_f32_16x16x32_bf16 v[52:55], v[196:199], v[240:243], v[52:55]
    v_mfma_f32_16x16x32_bf16 v[52:55], v[200:203], v[236:239], v[52:55]
    v_mfma_f32_16x16x32_bf16 v[52:55], v[204:207], v[232:235], v[52:55]
    buffer_load_dwordx4 v[148:151], v9, s[64:67], s88 offen offset:2048 sc1
    v_mfma_f32_16x16x32_bf16 v[52:55], v[208:211], v[228:231], v[52:55]
    v_mfma_f32_16x16x32_bf16 v[52:55], v[212:215], v[224:227], v[52:55]
    s_waitcnt lgkmcnt(3)
    s_nop 0
    v_mfma_f32_16x16x32_bf16 v[56:59], v[192:195], v[248:251], v[56:59]
    v_mfma_f32_16x16x32_bf16 v[56:59], v[196:199], v[244:247], v[56:59]
    buffer_load_dwordx4 v[152:155], v9, s[64:67], s89 offen offset:0 sc1
    v_mfma_f32_16x16x32_bf16 v[56:59], v[200:203], v[240:243], v[56:59]
    v_mfma_f32_16x16x32_bf16 v[56:59], v[204:207], v[236:239], v[56:59]
    v_mfma_f32_16x16x32_bf16 v[56:59], v[208:211], v[232:235], v[56:59]
    buffer_load_dwordx4 v[156:159], v9, s[64:67], s89 offen offset:2048 sc1
    v_mfma_f32_16x16x32_bf16 v[56:59], v[212:215], v[228:231], v[56:59]
    v_mfma_f32_16x16x32_bf16 v[56:59], v[216:219], v[224:227], v[56:59]
    s_waitcnt lgkmcnt(2)
    s_nop 0
    v_mfma_f32_16x16x32_bf16 v[60:63], v[192:195], v[252:255], v[60:63]
    v_mfma_f32_16x16x32_bf16 v[60:63], v[196:199], v[248:251], v[60:63]
    buffer_load_dwordx4 v[160:163], v9, s[64:67], s90 offen offset:0 sc1
    v_mfma_f32_16x16x32_bf16 v[60:63], v[200:203], v[244:247], v[60:63]
    v_mfma_f32_16x16x32_bf16 v[60:63], v[204:207], v[240:243], v[60:63]
    v_mfma_f32_16x16x32_bf16 v[60:63], v[208:211], v[236:239], v[60:63]
    buffer_load_dwordx4 v[164:167], v9, s[64:67], s90 offen offset:2048 sc1
    v_mfma_f32_16x16x32_bf16 v[60:63], v[212:215], v[232:235], v[60:63]
    v_mfma_f32_16x16x32_bf16 v[60:63], v[216:219], v[228:231], v[60:63]
    v_add_u32 v82, 4096, v82
    s_waitcnt lgkmcnt(0)
    v_mfma_f32_16x16x32_bf16 v[60:63], v[220:223], v[224:227], v[60:63]
    buffer_load_dword v126, v82, s[64:67], 0 offen sc1
    s_waitcnt vmcnt(10)
    v_mfma_f32_16x16x32_bf16 v[224:227], a[0:3], v[128:131], 0
    ds_read_b64 v[112:113], v69 offset:1536
    ds_read_b64 v[114:115], v69 offset:1024
    v_mfma_f32_16x16x32_bf16 v[228:231], a[4:7], v[128:131], 0
    buffer_load_dwordx4 v[168:171], v9, s[64:67], s91 offen offset:0 sc1
    ds_read_b64 v[116:117], v69 offset:512
    ds_read_b64 v[118:119], v69 offset:0
    v_mfma_f32_16x16x32_bf16 v[232:235], a[8:11], v[128:131], 0
    s_bitcmp1_b32 s3, 0
    s_cbranch_scc1 L_exb
    ds_write_b128 v95, v[48:51] offset:0
    ds_write_b128 v95, v[52:55] offset:1024
    ds_write_b128 v95, v[56:59] offset:2048
    ds_write_b128 v95, v[60:63] offset:3072
    s_branch L_exj
L_exb:
    ds_write_b128 v95, v[32:35] offset:0
    ds_write_b128 v95, v[36:39] offset:1024
    ds_write_b128 v95, v[40:43] offset:2048
    ds_write_b128 v95, v[44:47] offset:3072
L_exj:
    v_mfma_f32_16x16x32_bf16 v[236:239], a[12:15], v[128:131], 0
    buffer_load_dwordx4 v[172:175], v9, s[64:67], s91 offen offset:2048 sc1
    s_mov_b32 m0, s14
    s_waitcnt vmcnt(11)
    s_nop 0
    v_mfma_f32_16x16x32_bf16 v[224:227], a[16:19], v[132:135], v[224:227]
    buffer_load_dwordx4 v67, s[36:39], s46 offen lds
    buffer_load_dwordx4 v76, s[36:39], s46 offen offset:1024 lds
    v_mfma_f32_16x16x32_bf16 v[228:231], a[20:23], v[132:135], v[228:231]
    buffer_load_dwordx4 v[128:131], v9, s[64:67], s92 offen offset:0 sc1
    v_mfma_f32_16x16x32_bf16 v[232:235], a[24:27], v[132:135], v[232:235]
    v_mfma_f32_16x16x32_bf16 v[236:239], a[28:31], v[132:135], v[236:239]
    s_waitcnt lgkmcnt(0)
    s_barrier
    ds_read_b128 v[192:195], v120 offset:0
    ds_read_b128 v[196:199], v120 offset:1024
    ds_read_b128 v[200:203], v120 offset:2048
    ds_read_b128 v[204:207], v120 offset:3072
    s_waitcnt vmcnt(13)
    s_nop 0
    v_mfma_f32_16x16x32_bf16 v[224:227], a[32:35], v[136:139], v[224:227]
    v_mfma_f32_16x16x32_bf16 v[228:231], a[36:39], v[136:139], v[228:231]
    buffer_load_dwordx4 v[132:135], v9, s[64:67], s92 offen offset:2048 sc1
    v_mfma_f32_16x16x32_bf16 v[232:235], a[40:43], v[136:139], v[232:235]
    v_mfma_f32_16x16x32_bf16 v[236:239], a[44:47], v[136:139], v[236:239]
    s_waitcnt vmcnt(13)
    v_mfma_f32_16x16x32_bf16 v[224:227], a[48:51], v[140:143], v[224:227]
    s_waitcnt lgkmcnt(0)
    s_bitcmp1_b32 s3, 0
    s_cbranch_scc1 L_adb
    v_add_f32 v32, v32, v192
    v_add_f32 v33, v33, v193
    v_add_f32 v34, v34, v194
    v_add_f32 v35, v35, v195
    v_add_f32 v36, v36, v196
    v_add_f32 v37, v37, v197
    v_add_f32 v38, v38, v198
    v_add_f32 v39, v39, v199
    v_add_f32 v40, v40, v200
    v_add_f32 v41, v41, v201
    v_add_f32 v42, v42, v202
    v_add_f32 v43, v43, v203
    v_add_f32 v44, v44, v204
    v_add_f32 v45, v45, v205
    v_add_f32 v46, v46, v206
    v_add_f32 v47, v47, v207
    s_branch L_adj
L_adb:
    v_add_f32 v32, v48, v192
    v_add_f32 v33, v49, v193
    v_add_f32 v34, v50, v194
    v_add_f32 v35, v51, v195
    v_add_f32 v36, v52, v196
    v_add_f32 v37, v53, v197
    v_add_f32 v38, v54, v198
    v_add_f32 v39, v55, v199
    v_add_f32 v40, v56, v200
    v_add_f32 v41, v57, v201
    v_add_f32 v42, v58, v202
    v_add_f32 v43, v59, v203
    v_add_f32 v44, v60, v204
    v_add_f32 v45, v61, v205
    v_add_f32 v46, v62, v206
    v_add_f32_e64 v47, v63, v207
L_adj:
    v_mfma_f32_16x16x32_bf16 v[228:231], a[52:55], v[140:143], v[228:231]
    buffer_load_dwordx4 v[136:139], v9, s[64:67], s86 offen offset:256 sc1
    v_and_b32 v12, 0xffff0000, v113
    v_mfma_f32_16x16x32_bf16 v[232:235], a[56:59], v[140:143], v[232:235]
    v_lshlrev_b32_e64 v13, 16, v113
    v_and_b32 v14, 0xffff0000, v112
    v_lshlrev_b32_e64 v15, 16, v112
    v_mfma_f32_16x16x32_bf16 v[236:239], a[60:63], v[140:143], v[236:239]
    v_fmac_f32 v32, s45, v12
    v_fmac_f32 v33, s45, v13
    s_waitcnt vmcnt(13)
    v_mfma_f32_16x16x32_bf16 v[224:227], a[64:67], v[144:147], v[224:227]
    v_fmac_f32 v34, s45, v14
    v_fmac_f32_e64 v35, s45, v15
    v_mfma_f32_16x16x32_bf16 v[228:231], a[68:71], v[144:147], v[228:231]
    buffer_load_dwordx4 v[140:143], v9, s[64:67], s86 offen offset:2304 sc1
    v_mfma_f32_16x16x32_bf16 v[232:235], a[72:75], v[144:147], v[232:235]
    v_cvt_pk_bf16_f32 v96, v32, v33
    v_cvt_pk_bf16_f32 v97, v34, v35
    v_and_b32 v12, 0xffff0000, v115
    v_mfma_f32_16x16x32_bf16 v[236:239], a[76:79], v[144:147], v[236:239]
    v_lshlrev_b32_e64 v13, 16, v115
    v_and_b32 v14, 0xffff0000, v114
    s_waitcnt vmcnt(13)
    v_mfma_f32_16x16x32_bf16 v[224:227], a[80:83], v[148:151], v[224:227]
    v_lshlrev_b32 v15, 16, v114
    v_fmac_f32_e64 v36, s45, v12
    v_mfma_f32_16x16x32_bf16 v[228:231], a[84:87], v[148:151], v[228:231]
    buffer_load_dwordx4 v[144:147], v9, s[64:67], s87 offen offset:256 sc1
    v_mfma_f32_16x16x32_bf16 v[232:235], a[88:91], v[148:151], v[232:235]
    v_fmac_f32 v37, s45, v13
    v_fmac_f32 v38, s45, v14
    v_fmac_f32_e64 v39, s45, v15
    v_mfma_f32_16x16x32_bf16 v[236:239], a[92:95], v[148:151], v[236:239]
    v_cvt_pk_bf16_f32 v98, v36, v37
    v_cvt_pk_bf16_f32 v99, v38, v39
    s_waitcnt vmcnt(13)
    v_mfma_f32_16x16x32_bf16 v[224:227], a[96:99], v[152:155], v[224:227]
    v_and_b32 v12, 0xffff0000, v117
    v_lshlrev_b32 v13, 16, v117
    v_mfma_f32_16x16x32_bf16 v[228:231], a[100:103], v[152:155], v[228:231]
    buffer_load_dwordx4 v[148:151], v9, s[64:67], s87 offen offset:2304 sc1
    v_mfma_f32_16x16x32_bf16 v[232:235], a[104:107], v[152:155], v[232:235]
    v_and_b32 v14, 0xffff0000, v116
    v_lshlrev_b32 v15, 16, v116
    v_fmac_f32 v40, s45, v12
    v_mfma_f32_16x16x32_bf16 v[236:239], a[108:111], v[152:155], v[236:239]
    v_fmac_f32 v41, s45, v13
    v_fmac_f32 v42, s45, v14
    s_waitcnt vmcnt(13)
    v_mfma_f32_16x16x32_bf16 v[224:227], a[112:115], v[156:159], v[224:227]
    v_fmac_f32 v43, s45, v15
    v_cvt_pk_bf16_f32 v100, v40, v41
    v_mfma_f32_16x16x32_bf16 v[228:231], a[116:119], v[156:159], v[228:231]
    buffer_load_dwordx4 v[152:155], v9, s[64:67], s88 offen offset:256 sc1
    v_mfma_f32_16x16x32_bf16 v[232:235], a[120:123], v[156:159], v[232:235]
    v_cvt_pk_bf16_f32 v101, v42, v43
    v_and_b32 v12, 0xffff0000, v119
    v_lshlrev_b32_e64 v13, 16, v119
    v_mfma_f32_16x16x32_bf16 v[236:239], a[124:127], v[156:159], v[236:239]
    v_and_b32 v14, 0xffff0000, v118
    v_lshlrev_b32 v15, 16, v118
    s_waitcnt vmcnt(13)
    v_mfma_f32_16x16x32_bf16 v[224:227], a[128:131], v[160:163], v[224:227]
    v_fmac_f32 v44, s45, v12
    v_fmac_f32 v45, s45, v13
    v_mfma_f32_16x16x32_bf16 v[228:231], a[132:135], v[160:163], v[228:231]
    buffer_load_dwordx4 v[156:159], v9, s[64:67], s88 offen offset:2304 sc1
    v_mfma_f32_16x16x32_bf16 v[232:235], a[136:139], v[160:163], v[232:235]
    v_fmac_f32 v46, s45, v14
    v_fmac_f32 v47, s45, v15
    v_cvt_pk_bf16_f32 v102, v44, v45
    v_mfma_f32_16x16x32_bf16 v[236:239], a[140:143], v[160:163], v[236:239]
    v_cvt_pk_bf16_f32 v103, v46, v47
    v_permlane16_swap_b32 v96, v98
    s_waitcnt vmcnt(13)
    v_mfma_f32_16x16x32_bf16 v[224:227], a[144:147], v[164:167], v[224:227]
    v_permlane16_swap_b32 v97, v99
    v_permlane16_swap_b32 v100, v102
    v_mfma_f32_16x16x32_bf16 v[228:231], a[148:151], v[164:167], v[228:231]
    buffer_load_dwordx4 v[160:163], v9, s[64:67], s89 offen offset:256 sc1
    v_permlane16_swap_b32 v101, v103
    s_nop 0
    v_mfma_f32_16x16x32_bf16 v[232:235], a[152:155], v[164:167], v[232:235]
    buffer_store_dwordx4 v[96:99], v68, s[64:67], s31 offen offset:0 sc1
    v_mfma_f32_16x16x32_bf16 v[236:239], a[156:159], v[164:167], v[236:239]
    buffer_store_dwordx4 v[100:103], v68, s[64:67], s31 offen offset:1024 sc1
    s_waitcnt vmcnt(14)
    s_nop 0
    v_mfma_f32_16x16x32_bf16 v[224:227], a[160:163], v[168:171], v[224:227]
    buffer_load_dwordx2 v[24:25], v65, s[64:67], 0 offen offset:0 sc1
    v_mfma_f32_16x16x32_bf16 v[228:231], a[164:167], v[168:171], v[228:231]
    buffer_load_dwordx4 v[164:167], v9, s[64:67], s89 offen offset:2304 sc1
    v_mfma_f32_16x16x32_bf16 v[232:235], a[168:171], v[168:171], v[232:235]
    v_mfma_f32_16x16x32_bf16 v[236:239], a[172:175], v[168:171], v[236:239]
    buffer_load_dwordx2 v[26:27], v65, s[64:67], 0 offen offset:128 sc1
    s_waitcnt vmcnt(16)
    s_nop 0
    v_mfma_f32_16x16x32_bf16 v[224:227], a[176:179], v[172:175], v[224:227]
    v_mfma_f32_16x16x32_bf16 v[228:231], a[180:183], v[172:175], v[228:231]
    buffer_load_dwordx4 v[168:171], v9, s[64:67], s90 offen offset:256 sc1
    v_mfma_f32_16x16x32_bf16 v[232:235], a[184:187], v[172:175], v[232:235]
    buffer_load_dwordx2 v[28:29], v65, s[64:67], 0 offen offset:256 sc1
    v_mfma_f32_16x16x32_bf16 v[236:239], a[188:191], v[172:175], v[236:239]
    s_waitcnt vmcnt(15)
    s_nop 0
    v_mfma_f32_16x16x32_bf16 v[224:227], a[192:195], v[128:131], v[224:227]
    v_mfma_f32_16x16x32_bf16 v[228:231], a[196:199], v[128:131], v[228:231]
    buffer_load_dwordx4 v[172:175], v9, s[64:67], s90 offen offset:2304 sc1
    v_mfma_f32_16x16x32_bf16 v[232:235], a[200:203], v[128:131], v[232:235]
    buffer_load_dwordx2 v[30:31], v65, s[64:67], 0 offen offset:384 sc1
    v_mfma_f32_16x16x32_bf16 v[236:239], a[204:207], v[128:131], v[236:239]
    s_waitcnt vmcnt(16)
    s_nop 0
    v_mfma_f32_16x16x32_bf16 v[224:227], a[208:211], v[132:135], v[224:227]
    v_mfma_f32_16x16x32_bf16 v[228:231], a[212:215], v[132:135], v[228:231]
    buffer_load_dwordx4 v[128:131], v9, s[64:67], s91 offen offset:256 sc1
    v_mfma_f32_16x16x32_bf16 v[232:235], a[216:219], v[132:135], v[232:235]
    v_mfma_f32_16x16x32_bf16 v[236:239], a[220:223], v[132:135], v[236:239]
    s_waitcnt vmcnt(16)
    s_nop 0
    v_mfma_f32_16x16x32_bf16 v[32:35], a[0:3], v[136:139], 0
    v_mfma_f32_16x16x32_bf16 v[36:39], a[4:7], v[136:139], 0
    buffer_load_dwordx4 v[132:135], v9, s[64:67], s91 offen offset:2304 sc1
    v_mfma_f32_16x16x32_bf16 v[40:43], a[8:11], v[136:139], 0
    v_mfma_f32_16x16x32_bf16 v[44:47], a[12:15], v[136:139], 0
    s_waitcnt vmcnt(16)
    s_nop 0
    v_mfma_f32_16x16x32_bf16 v[32:35], a[16:19], v[140:143], v[32:35]
    ds_write_b128 v121, v[224:227] offset:0
    v_mfma_f32_16x16x32_bf16 v[36:39], a[20:23], v[140:143], v[36:39]
    buffer_load_dwordx4 v[136:139], v9, s[64:67], s92 offen offset:256 sc1
    v_mfma_f32_16x16x32_bf16 v[40:43], a[24:27], v[140:143], v[40:43]
    ds_write_b128 v121, v[228:231] offset:4096
    ds_write_b128 v121, v[232:235] offset:8192
    v_mfma_f32_16x16x32_bf16 v[44:47], a[28:31], v[140:143], v[44:47]
    ds_write_b128 v121, v[236:239] offset:12288
    s_waitcnt vmcnt(16)
    s_nop 0
    v_mfma_f32_16x16x32_bf16 v[32:35], a[32:35], v[144:147], v[32:35]
    v_mfma_f32_16x16x32_bf16 v[36:39], a[36:39], v[144:147], v[36:39]
    buffer_load_dwordx4 v[140:143], v9, s[64:67], s92 offen offset:2304 sc1
    v_mfma_f32_16x16x32_bf16 v[40:43], a[40:43], v[144:147], v[40:43]
    v_mfma_f32_16x16x32_bf16 v[44:47], a[44:47], v[144:147], v[44:47]
    v_cmp_ne_u32 vcc, s21, v126
    s_nop 0
    s_cbranch_vccnz L_hb_slow
L_hb_ok:
    s_waitcnt vmcnt(11) lgkmcnt(0)
    s_barrier
    s_or_b32 s78, s43, s20
    v_mov_b32 v10, s78
    v_mov_b32 v11, s6
    s_mov_b64 exec, 1
    buffer_store_dword v11, v10, s[64:67], 0 offen sc1
    s_mov_b64 exec, -1
    v_mfma_f32_16x16x32_bf16 v[32:35], a[48:51], v[148:151], v[32:35]
    ds_read_b128 v[192:195], v123 offset:0
    ds_read_b64 v[84:85], v77 offset:0
    v_mfma_f32_16x16x32_bf16 v[36:39], a[52:55], v[148:151], v[36:39]
    buffer_load_dwordx4 v[144:147], v18, s[64:67], s86 offen offset:0 sc1
    v_mfma_f32_16x16x32_bf16 v[40:43], a[56:59], v[148:151], v[40:43]
    ds_read_b128 v[196:199], v123 offset:1024
    ds_read_b64 v[86:87], v77 offset:2048
    ds_read_b128 v[200:203], v123 offset:2048
    v_mfma_f32_16x16x32_bf16 v[44:47], a[60:63], v[148:151], v[44:47]
    ds_read_b64 v[88:89], v77 offset:4096
    ds_read_b128 v[204:207], v123 offset:3072
    v_mfma_f32_16x16x32_bf16 v[32:35], a[64:67], v[152:155], v[32:35]
    ds_read_b64 v[90:91], v77 offset:6144
    v_mfma_f32_16x16x32_bf16 v[36:39], a[68:71], v[152:155], v[36:39]
    buffer_load_dwordx4 v[148:151], v18, s[64:67], s86 offen offset:2048 sc1
    v_mfma_f32_16x16x32_bf16 v[40:43], a[72:75], v[152:155], v[40:43]
    s_waitcnt lgkmcnt(5)
    v_add_f32 v192, v192, v196
    v_mfma_f32_16x16x32_bf16 v[44:47], a[76:79], v[152:155], v[44:47]
    v_add_f32_e64 v193, v193, v197
    v_mfma_f32_16x16x32_bf16 v[32:35], a[80:83], v[156:159], v[32:35]
    v_add_f32_e64 v194, v194, v198
    v_mfma_f32_16x16x32_bf16 v[36:39], a[84:87], v[156:159], v[36:39]
    buffer_load_dwordx4 v[152:155], v18, s[64:67], s87 offen offset:0 sc1
    v_mfma_f32_16x16x32_bf16 v[40:43], a[88:91], v[156:159], v[40:43]
    v_add_f32 v195, v195, v199
    s_waitcnt lgkmcnt(1)
    v_add_f32_e64 v200, v200, v204
    v_mfma_f32_16x16x32_bf16 v[44:47], a[92:95], v[156:159], v[44:47]
    v_add_f32 v201, v201, v205
    v_add_f32 v202, v202, v206
    v_mfma_f32_16x16x32_bf16 v[32:35], a[96:99], v[160:163], v[32:35]
    v_add_f32_e64 v203, v203, v207
    v_mfma_f32_16x16x32_bf16 v[36:39], a[100:103], v[160:163], v[36:39]
    buffer_load_dwordx4 v[156:159], v18, s[64:67], s87 offen offset:2048 sc1
    v_mfma_f32_16x16x32_bf16 v[40:43], a[104:107], v[160:163], v[40:43]
    v_add_f32 v208, v192, v200
    v_add_f32 v209, v193, v201
    v_mfma_f32_16x16x32_bf16 v[44:47], a[108:111], v[160:163], v[44:47]
    v_add_f32 v210, v194, v202
    v_add_f32 v211, v195, v203
    s_waitcnt vmcnt(14)
    v_mfma_f32_16x16x32_bf16 v[32:35], a[112:115], v[164:167], v[32:35]
    v_rsq_f32 v25, v25
    v_lshlrev_b32_e64 v176, 16, v84
    v_mfma_f32_16x16x32_bf16 v[36:39], a[116:119], v[164:167], v[36:39]
    buffer_load_dwordx4 v[160:163], v18, s[64:67], s88 offen offset:0 sc1
    v_mfma_f32_16x16x32_bf16 v[40:43], a[120:123], v[164:167], v[40:43]
    v_and_b32 v177, 0xffff0000, v84
    v_lshlrev_b32_e64 v178, 16, v85
    v_mfma_f32_16x16x32_bf16 v[44:47], a[124:127], v[164:167], v[44:47]
    v_and_b32 v179, 0xffff0000, v85
    v_sub_f32 v104, v176, v24
    s_waitcnt vmcnt(13)
    v_mfma_f32_16x16x32_bf16 v[32:35], a[128:131], v[168:171], v[32:35]
    v_sub_f32_e64 v105, v177, v24
    v_mfma_f32_16x16x32_bf16 v[36:39], a[132:135], v[168:171], v[36:39]
    buffer_load_dwordx4 v[164:167], v18, s[64:67], s88 offen offset:2048 sc1
    v_mfma_f32_16x16x32_bf16 v[40:43], a[136:139], v[168:171], v[40:43]
    v_sub_f32 v106, v178, v24
    v_sub_f32 v107, v179, v24
    v_mfma_f32_16x16x32_bf16 v[44:47], a[140:143], v[168:171], v[44:47]
    v_mul_f32 v104, v104, v25
    v_mul_f32 v105, v105, v25
    s_waitcnt vmcnt(12)
    v_mfma_f32_16x16x32_bf16 v[32:35], a[144:147], v[172:175], v[32:35]
    v_mul_f32 v106, v106, v25
    v_mfma_f32_16x16x32_bf16 v[36:39], a[148:151], v[172:175], v[36:39]
    buffer_load_dwordx4 v[168:171], v18, s[64:67], s89 offen offset:0 sc1
    v_mfma_f32_16x16x32_bf16 v[40:43], a[152:155], v[172:175], v[40:43]
    v_mul_f32_e64 v107, v107, v25
    v_mul_f32 v240, 0xbfb8aa3b, v208
    v_mul_f32 v241, 0xbfb8aa3b, v209
    v_mfma_f32_16x16x32_bf16 v[44:47], a[156:159], v[172:175], v[44:47]
    v_mul_f32 v242, 0xbfb8aa3b, v210
    v_mul_f32 v243, 0xbfb8aa3b, v211
    s_waitcnt vmcnt(11)
    v_mfma_f32_16x16x32_bf16 v[32:35], a[160:163], v[128:131], v[32:35]
    v_exp_f32 v240, v240
    v_mfma_f32_16x16x32_bf16 v[36:39], a[164:167], v[128:131], v[36:39]
    buffer_load_dwordx4 v[172:175], v18, s[64:67], s89 offen offset:2048 sc1
    v_mfma_f32_16x16x32_bf16 v[40:43], a[168:171], v[128:131], v[40:43]
    v_exp_f32 v241, v241
    v_exp_f32 v242, v242
    v_mfma_f32_16x16x32_bf16 v[44:47], a[172:175], v[128:131], v[44:47]
    v_exp_f32 v243, v243
    v_mul_f32 v104, v104, v208
    s_waitcnt vmcnt(11)
    v_mfma_f32_16x16x32_bf16 v[32:35], a[176:179], v[132:135], v[32:35]
    v_mul_f32 v105, v105, v209
    v_rsq_f32 v27, v27
    v_lshlrev_b32 v180, 16, v86
    v_mfma_f32_16x16x32_bf16 v[36:39], a[180:183], v[132:135], v[36:39]
    buffer_load_dwordx4 v[128:131], v18, s[64:67], s90 offen offset:0 sc1
    v_mul_f32_e64 v106, v106, v210
    v_mfma_f32_16x16x32_bf16 v[40:43], a[184:187], v[132:135], v[40:43]
    v_and_b32 v181, 0xffff0000, v86
    v_mul_f32 v107, v107, v211
    v_add_f32 v240, 1.0, v240
    v_mfma_f32_16x16x32_bf16 v[44:47], a[188:191], v[132:135], v[44:47]
    v_lshlrev_b32 v182, 16, v87
    v_add_f32 v241, 1.0, v241
    v_and_b32 v183, 0xffff0000, v87
    v_add_f32 v242, 1.0, v242
    s_waitcnt vmcnt(11)
    v_mfma_f32_16x16x32_bf16 v[32:35], a[192:195], v[136:139], v[32:35]
    v_sub_f32_e64 v108, v180, v26
    buffer_load_dwordx4 v[132:135], v18, s[64:67], s90 offen offset:2048 sc1
    v_mfma_f32_16x16x32_bf16 v[36:39], a[196:199], v[136:139], v[36:39]
    v_add_f32 v243, 1.0, v243
    v_rcp_f32 v240, v240
    v_mfma_f32_16x16x32_bf16 v[40:43], a[200:203], v[136:139], v[40:43]
    v_sub_f32 v109, v181, v26
    v_rcp_f32 v241, v241
    v_sub_f32_e64 v110, v182, v26
    v_mfma_f32_16x16x32_bf16 v[44:47], a[204:207], v[136:139], v[44:47]
    v_rcp_f32 v242, v242
    v_sub_f32 v111, v183, v26
    s_waitcnt vmcnt(11)
    v_mfma_f32_16x16x32_bf16 v[32:35], a[208:211], v[140:143], v[32:35]
    v_rcp_f32 v243, v243
    v_mul_f32 v104, v104, v240
    v_mul_f32 v108, v108, v27
    v_mfma_f32_16x16x32_bf16 v[36:39], a[212:215], v[140:143], v[36:39]
    buffer_load_dwordx4 v[136:139], v18, s[64:67], s91 offen offset:0 sc1
    v_mul_f32_e64 v105, v105, v241
    v_mfma_f32_16x16x32_bf16 v[40:43], a[216:219], v[140:143], v[40:43]
    v_mul_f32 v109, v109, v27
    v_mul_f32 v106, v106, v242
    v_mul_f32_e64 v110, v110, v27
    v_mfma_f32_16x16x32_bf16 v[44:47], a[220:223], v[140:143], v[44:47]
    v_mul_f32 v107, v107, v243
    v_mul_f32 v111, v111, v27
    s_waitcnt vmcnt(10)
    v_mfma_f32_16x16x32_bf16 v[48:51], a[0:3], v[144:147], 0
    v_rsq_f32 v29, v29
    v_mfma_f32_16x16x32_bf16 v[52:55], a[4:7], v[144:147], 0
    buffer_load_dwordx4 v[140:143], v18, s[64:67], s91 offen offset:2048 sc1
    v_mfma_f32_16x16x32_bf16 v[56:59], a[8:11], v[144:147], 0
    v_lshlrev_b32_e64 v184, 16, v88
    v_mfma_f32_16x16x32_bf16 v[60:63], a[12:15], v[144:147], 0
    ds_write_b128 v121, v[32:35] offset:16384
    v_and_b32 v185, 0xffff0000, v88
    s_waitcnt vmcnt(10)
    s_nop 0
    v_mfma_f32_16x16x32_bf16 v[48:51], a[16:19], v[148:151], v[48:51]
    buffer_load_dwordx4 v[144:147], v18, s[64:67], s92 offen offset:0 sc1
    v_mfma_f32_16x16x32_bf16 v[52:55], a[20:23], v[148:151], v[52:55]
    ds_write_b128 v121, v[36:39] offset:20480
    v_mfma_f32_16x16x32_bf16 v[56:59], a[24:27], v[148:151], v[56:59]
    ds_write_b128 v121, v[40:43] offset:24576
    v_lshlrev_b32_e64 v186, 16, v89
    v_mfma_f32_16x16x32_bf16 v[60:63], a[28:31], v[148:151], v[60:63]
    ds_write_b128 v121, v[44:47] offset:28672
    s_waitcnt vmcnt(10)
    s_nop 0
    v_mfma_f32_16x16x32_bf16 v[48:51], a[32:35], v[152:155], v[48:51]
    v_and_b32 v187, 0xffff0000, v89
    v_mfma_f32_16x16x32_bf16 v[52:55], a[36:39], v[152:155], v[52:55]
    buffer_load_dwordx4 v[148:151], v18, s[64:67], s92 offen offset:2048 sc1
    v_mfma_f32_16x16x32_bf16 v[56:59], a[40:43], v[152:155], v[56:59]
    v_sub_f32_e64 v112, v184, v28
    v_mfma_f32_16x16x32_bf16 v[60:63], a[44:47], v[152:155], v[60:63]
    s_waitcnt lgkmcnt(0)
    s_barrier
    s_waitcnt vmcnt(10)
    v_mfma_f32_16x16x32_bf16 v[48:51], a[48:51], v[156:159], v[48:51]
    ds_read_b128 v[192:195], v123 offset:16384
    v_sub_f32 v113, v185, v28
    v_mfma_f32_16x16x32_bf16 v[52:55], a[52:55], v[156:159], v[52:55]
    buffer_load_dwordx4 v[152:155], v18, s[64:67], s86 offen offset:256 sc1
    v_mfma_f32_16x16x32_bf16 v[56:59], a[56:59], v[156:159], v[56:59]
    ds_read_b128 v[196:199], v123 offset:17408
    ds_read_b128 v[200:203], v123 offset:18432
    v_mfma_f32_16x16x32_bf16 v[60:63], a[60:63], v[156:159], v[60:63]
    ds_read_b128 v[204:207], v123 offset:19456
    s_waitcnt vmcnt(10)
    v_mfma_f32_16x16x32_bf16 v[48:51], a[64:67], v[160:163], v[48:51]
    v_sub_f32 v114, v186, v28
    v_mfma_f32_16x16x32_bf16 v[52:55], a[68:71], v[160:163], v[52:55]
    buffer_load_dwordx4 v[156:159], v18, s[64:67], s86 offen offset:2304 sc1
    v_mfma_f32_16x16x32_bf16 v[56:59], a[72:75], v[160:163], v[56:59]
    v_sub_f32_e64 v115, v187, v28
    v_mfma_f32_16x16x32_bf16 v[60:63], a[76:79], v[160:163], v[60:63]
    s_waitcnt lgkmcnt(2)
    v_add_f32 v192, v192, v196
    v_mul_f32 v112, v112, v29
    s_waitcnt vmcnt(10)
    v_mfma_f32_16x16x32_bf16 v[48:51], a[80:83], v[164:167], v[48:51]
    v_add_f32_e64 v193, v193, v197
    v_mfma_f32_16x16x32_bf16 v[52:55], a[84:87], v[164:167], v[52:55]
    buffer_load_dwordx4 v[160:163], v18, s[64:67], s87 offen offset:256 sc1
    v_mfma_f32_16x16x32_bf16 v[56:59], a[88:91], v[164:167], v[56:59]
    v_add_f32 v194, v194, v198
    v_mul_f32 v113, v113, v29
    v_add_f32_e64 v195, v195, v199
    v_mfma_f32_16x16x32_bf16 v[60:63], a[92:95], v[164:167], v[60:63]
    s_waitcnt lgkmcnt(0)
    v_add_f32 v200, v200, v204
    v_mul_f32 v114, v114, v29
    s_waitcnt vmcnt(10)
    v_mfma_f32_16x16x32_bf16 v[48:51], a[96:99], v[168:171], v[48:51]
    v_add_f32_e64 v201, v201, v205
    v_mfma_f32_16x16x32_bf16 v[52:55], a[100:103], v[168:171], v[52:55]
    buffer_load_dwordx4 v[164:167], v18, s[64:67], s87 offen offset:2304 sc1
    v_mfma_f32_16x16x32_bf16 v[56:59], a[104:107], v[168:171], v[56:59]
    v_add_f32 v202, v202, v206
    v_mul_f32 v115, v115, v29
    v_add_f32_e64 v203, v203, v207
    v_mfma_f32_16x16x32_bf16 v[60:63], a[108:111], v[168:171], v[60:63]
    v_add_f32 v208, v192, v200
    v_add_f32 v209, v193, v201
    s_waitcnt vmcnt(10)
    v_mfma_f32_16x16x32_bf16 v[48:51], a[112:115], v[172:175], v[48:51]
    v_rsq_f32 v31, v31
    v_mfma_f32_16x16x32_bf16 v[52:55], a[116:119], v[172:175], v[52:55]
    buffer_load_dwordx4 v[168:171], v18, s[64:67], s88 offen offset:256 sc1
    v_mfma_f32_16x16x32_bf16 v[56:59], a[120:123], v[172:175], v[56:59]
    v_add_f32 v210, v194, v202
    v_add_f32 v211, v195, v203
    v_mfma_f32_16x16x32_bf16 v[60:63], a[124:127], v[172:175], v[60:63]
    v_lshlrev_b32_e64 v188, 16, v90
    v_mul_f32 v240, 0xbfb8aa3b, v208
    s_waitcnt vmcnt(10)
    s_nop 0
    v_mfma_f32_16x16x32_bf16 v[48:51], a[128:131], v[128:131], v[48:51]
    v_mul_f32 v241, 0xbfb8aa3b, v209
    v_and_b32 v189, 0xffff0000, v90
    v_mfma_f32_16x16x32_bf16 v[52:55], a[132:135], v[128:131], v[52:55]
    buffer_load_dwordx4 v[172:175], v18, s[64:67], s88 offen offset:2304 sc1
    v_mul_f32 v242, 0xbfb8aa3b, v210
    v_mfma_f32_16x16x32_bf16 v[56:59], a[136:139], v[128:131], v[56:59]
    v_mul_f32 v243, 0xbfb8aa3b, v211
    v_lshlrev_b32_e64 v190, 16, v91
    buffer_load_dword v127, v81, s[64:67], 0 offen sc1
    v_mfma_f32_16x16x32_bf16 v[60:63], a[140:143], v[128:131], v[60:63]
    v_exp_f32 v240, v240
    s_waitcnt vmcnt(11)
    v_mfma_f32_16x16x32_bf16 v[48:51], a[144:147], v[132:135], v[48:51]
    v_exp_f32_e64 v241, v241
    v_and_b32 v191, 0xffff0000, v91
    v_mfma_f32_16x16x32_bf16 v[52:55], a[148:151], v[132:135], v[52:55]
    buffer_load_dwordx4 v[128:131], v18, s[64:67], s89 offen offset:256 sc1
    v_mfma_f32_16x16x32_bf16 v[56:59], a[152:155], v[132:135], v[56:59]
    v_exp_f32 v242, v242
    v_exp_f32 v243, v243
    v_mfma_f32_16x16x32_bf16 v[60:63], a[156:159], v[132:135], v[60:63]
    v_sub_f32 v116, v188, v30
    v_mul_f32 v108, v108, v208
    s_waitcnt vmcnt(11)
    v_mfma_f32_16x16x32_bf16 v[48:51], a[160:163], v[136:139], v[48:51]
    v_mul_f32 v109, v109, v209
    v_sub_f32_e64 v117, v189, v30
    v_mfma_f32_16x16x32_bf16 v[52:55], a[164:167], v[136:139], v[52:55]
    buffer_load_dwordx4 v[132:135], v18, s[64:67], s89 offen offset:2304 sc1
    v_mfma_f32_16x16x32_bf16 v[56:59], a[168:171], v[136:139], v[56:59]
    v_mul_f32 v110, v110, v210
    v_mul_f32 v111, v111, v211
    v_mfma_f32_16x16x32_bf16 v[60:63], a[172:175], v[136:139], v[60:63]
    v_add_f32 v240, 1.0, v240
    v_sub_f32 v118, v190, v30
    s_waitcnt vmcnt(11)
    v_mfma_f32_16x16x32_bf16 v[48:51], a[176:179], v[140:143], v[48:51]
    v_add_f32 v241, 1.0, v241
    v_mfma_f32_16x16x32_bf16 v[52:55], a[180:183], v[140:143], v[52:55]
    buffer_load_dwordx4 v[136:139], v18, s[64:67], s90 offen offset:256 sc1
    v_mfma_f32_16x16x32_bf16 v[56:59], a[184:187], v[140:143], v[56:59]
    v_add_f32 v242, 1.0, v242
    v_sub_f32 v119, v191, v30
    v_add_f32_e64 v243, 1.0, v243
    v_mfma_f32_16x16x32_bf16 v[60:63], a[188:191], v[140:143], v[60:63]
    v_rcp_f32 v240, v240
    v_mul_f32 v116, v116, v31
    s_waitcnt vmcnt(11)
    v_mfma_f32_16x16x32_bf16 v[48:51], a[192:195], v[144:147], v[48:51]
    v_rcp_f32 v241, v241
    v_mfma_f32_16x16x32_bf16 v[52:55], a[196:199], v[144:147], v[52:55]
    buffer_load_dwordx4 v[140:143], v18, s[64:67], s90 offen offset:2304 sc1
    v_rcp_f32_e64 v242, v242
    v_mfma_f32_16x16x32_bf16 v[56:59], a[200:203], v[144:147], v[56:59]
    v_mul_f32 v117, v117, v31
    v_rcp_f32 v243, v243
    v_mfma_f32_16x16x32_bf16 v[60:63], a[204:207], v[144:147], v[60:63]
    v_mul_f32 v108, v108, v240
    v_mul_f32 v118, v118, v31
    s_waitcnt vmcnt(11)
    v_mfma_f32_16x16x32_bf16 v[48:51], a[208:211], v[148:151], v[48:51]
    v_mul_f32 v109, v109, v241
    v_mfma_f32_16x16x32_bf16 v[52:55], a[212:215], v[148:151], v[52:55]
    buffer_load_dwordx4 v[144:147], v18, s[64:67], s91 offen offset:256 sc1
    v_mfma_f32_16x16x32_bf16 v[56:59], a[216:219], v[148:151], v[56:59]
    v_mul_f32 v110, v110, v242
    v_mul_f32 v119, v119, v31
    v_mfma_f32_16x16x32_bf16 v[60:63], a[220:223], v[148:151], v[60:63]
    v_mul_f32 v111, v111, v243
    s_waitcnt vmcnt(11)
    v_mfma_f32_16x16x32_bf16 v[32:35], a[0:3], v[152:155], 0
    v_mfma_f32_16x16x32_bf16 v[36:39], a[4:7], v[152:155], 0
    buffer_load_dwordx4 v[148:151], v18, s[64:67], s91 offen offset:2304 sc1
    v_mfma_f32_16x16x32_bf16 v[40:43], a[8:11], v[152:155], 0
    s_waitcnt vmcnt(6)
    v_cmp_ne_u32 vcc, s21, v127
    s_nop 0
    s_cbranch_vccnz L_yf_slow
L_yf_ok:
    s_barrier
    s_nop 0
    buffer_load_dwordx4 v[244:247], v78, s[64:67], s16 offen sc1
    buffer_load_dwordx4 v[248:251], v78, s[64:67], s17 offen sc1
    v_mfma_f32_16x16x32_bf16 v[44:47], a[12:15], v[152:155], 0
    v_mfma_f32_16x16x32_bf16 v[32:35], a[16:19], v[156:159], v[32:35]
    ds_write_b128 v121, v[48:51] offset:0
    v_mfma_f32_16x16x32_bf16 v[36:39], a[20:23], v[156:159], v[36:39]
    buffer_load_dwordx4 v[152:155], v18, s[64:67], s92 offen offset:256 sc1
    v_mfma_f32_16x16x32_bf16 v[40:43], a[24:27], v[156:159], v[40:43]
    ds_write_b128 v121, v[52:55] offset:4096
    ds_write_b128 v121, v[56:59] offset:8192
    v_mfma_f32_16x16x32_bf16 v[44:47], a[28:31], v[156:159], v[44:47]
    ds_write_b128 v121, v[60:63] offset:12288
    v_mfma_f32_16x16x32_bf16 v[32:35], a[32:35], v[160:163], v[32:35]
    v_mfma_f32_16x16x32_bf16 v[36:39], a[36:39], v[160:163], v[36:39]
    buffer_load_dwordx4 v[156:159], v18, s[64:67], s92 offen offset:2304 sc1
    v_mfma_f32_16x16x32_bf16 v[40:43], a[40:43], v[160:163], v[40:43]
    v_mfma_f32_16x16x32_bf16 v[44:47], a[44:47], v[160:163], v[44:47]
    s_waitcnt lgkmcnt(0)
    s_barrier
    v_mfma_f32_16x16x32_bf16 v[32:35], a[48:51], v[164:167], v[32:35]
    ds_read_b128 v[192:195], v123 offset:0
    v_mfma_f32_16x16x32_bf16 v[36:39], a[52:55], v[164:167], v[36:39]
    ds_read_b128 v[196:199], v123 offset:1024
    v_mfma_f32_16x16x32_bf16 v[40:43], a[56:59], v[164:167], v[40:43]
    ds_read_b128 v[200:203], v123 offset:2048
    v_mfma_f32_16x16x32_bf16 v[44:47], a[60:63], v[164:167], v[44:47]
    ds_read_b128 v[204:207], v123 offset:3072
    v_mfma_f32_16x16x32_bf16 v[32:35], a[64:67], v[168:171], v[32:35]
    v_mfma_f32_16x16x32_bf16 v[36:39], a[68:71], v[168:171], v[36:39]
    v_mfma_f32_16x16x32_bf16 v[40:43], a[72:75], v[168:171], v[40:43]
    s_waitcnt lgkmcnt(2)
    v_add_f32 v192, v192, v196
    v_mfma_f32_16x16x32_bf16 v[44:47], a[76:79], v[168:171], v[44:47]
    v_add_f32_e64 v193, v193, v197
    v_mfma_f32_16x16x32_bf16 v[32:35], a[80:83], v[172:175], v[32:35]
    v_add_f32 v194, v194, v198
    v_add_f32 v195, v195, v199
    v_mfma_f32_16x16x32_bf16 v[36:39], a[84:87], v[172:175], v[36:39]
    s_waitcnt lgkmcnt(0)
    v_add_f32 v200, v200, v204
    v_add_f32_e64 v201, v201, v205
    v_mfma_f32_16x16x32_bf16 v[40:43], a[88:91], v[172:175], v[40:43]
    v_add_f32 v202, v202, v206
    v_add_f32 v203, v203, v207
    v_mfma_f32_16x16x32_bf16 v[44:47], a[92:95], v[172:175], v[44:47]
    v_add_f32 v208, v192, v200
    s_waitcnt vmcnt(9)
    v_mfma_f32_16x16x32_bf16 v[32:35], a[96:99], v[128:131], v[32:35]
    v_add_f32 v209, v193, v201
    v_add_f32 v210, v194, v202
    v_mfma_f32_16x16x32_bf16 v[36:39], a[100:103], v[128:131], v[36:39]
    v_add_f32_e64 v211, v195, v203
    v_mul_f32 v240, 0xbfb8aa3b, v208
    v_mfma_f32_16x16x32_bf16 v[40:43], a[104:107], v[128:131], v[40:43]
    v_mul_f32 v241, 0xbfb8aa3b, v209
    v_mul_f32 v242, 0xbfb8aa3b, v210
    v_mfma_f32_16x16x32_bf16 v[44:47], a[108:111], v[128:131], v[44:47]
    v_mul_f32 v243, 0xbfb8aa3b, v211
    v_exp_f32 v240, v240
    s_waitcnt vmcnt(8)
    v_mfma_f32_16x16x32_bf16 v[32:35], a[112:115], v[132:135], v[32:35]
    v_exp_f32_e64 v241, v241
    v_mfma_f32_16x16x32_bf16 v[36:39], a[116:119], v[132:135], v[36:39]
    v_exp_f32 v242, v242
    v_exp_f32 v243, v243
    v_mfma_f32_16x16x32_bf16 v[40:43], a[120:123], v[132:135], v[40:43]
    v_mul_f32 v112, v112, v208
    v_mul_f32 v113, v113, v209
    v_mfma_f32_16x16x32_bf16 v[44:47], a[124:127], v[132:135], v[44:47]
    v_mul_f32 v114, v114, v210
    v_mul_f32 v115, v115, v211
    s_waitcnt vmcnt(7)
    v_mfma_f32_16x16x32_bf16 v[32:35], a[128:131], v[136:139], v[32:35]
    v_add_f32 v240, 1.0, v240
    v_add_f32_e64 v241, 1.0, v241
    v_mfma_f32_16x16x32_bf16 v[36:39], a[132:135], v[136:139], v[36:39]
    v_add_f32 v242, 1.0, v242
    v_add_f32 v243, 1.0, v243
    v_mfma_f32_16x16x32_bf16 v[40:43], a[136:139], v[136:139], v[40:43]
    v_rcp_f32_e64 v240, v240
    v_mfma_f32_16x16x32_bf16 v[44:47], a[140:143], v[136:139], v[44:47]
    v_rcp_f32 v241, v241
    v_rcp_f32 v242, v242
    s_waitcnt vmcnt(6)
    v_mfma_f32_16x16x32_bf16 v[32:35], a[144:147], v[140:143], v[32:35]
    v_rcp_f32 v243, v243
    v_mul_f32_e64 v112, v112, v240
    v_mfma_f32_16x16x32_bf16 v[36:39], a[148:151], v[140:143], v[36:39]
    s_waitcnt vmcnt(3)
    ds_write_b128 v79, v[244:247]
    v_mul_f32 v113, v113, v241
    v_mfma_f32_16x16x32_bf16 v[40:43], a[152:155], v[140:143], v[40:43]
    v_mul_f32 v114, v114, v242
    s_waitcnt vmcnt(2)
    ds_write_b128 v79, v[248:251] offset:1280
    v_mfma_f32_16x16x32_bf16 v[44:47], a[156:159], v[140:143], v[44:47]
    v_mul_f32_e64 v115, v115, v243
    v_mfma_f32_16x16x32_bf16 v[32:35], a[160:163], v[144:147], v[32:35]
    s_waitcnt lgkmcnt(0)
    s_nop 0
    ds_read_b64_tr_b16 v[96:97], v80 offset:0
    v_mfma_f32_16x16x32_bf16 v[36:39], a[164:167], v[144:147], v[36:39]
    ds_read_b64_tr_b16 v[98:99], v80 offset:32
    ds_read_b64_tr_b16 v[100:101], v80 offset:64
    v_mfma_f32_16x16x32_bf16 v[40:43], a[168:171], v[144:147], v[40:43]
    ds_read_b64_tr_b16 v[102:103], v80 offset:96
    v_mfma_f32_16x16x32_bf16 v[44:47], a[172:175], v[144:147], v[44:47]
    s_waitcnt lgkmcnt(3)
    v_lshlrev_b32 v244, 16, v96
    v_mfma_f32_16x16x32_bf16 v[32:35], a[176:179], v[148:151], v[32:35]
    v_and_b32 v245, 0xffff0000, v96
    v_mfma_f32_16x16x32_bf16 v[36:39], a[180:183], v[148:151], v[36:39]
    v_lshlrev_b32_e64 v246, 16, v97
    v_and_b32 v247, 0xffff0000, v97
    v_mfma_f32_16x16x32_bf16 v[40:43], a[184:187], v[148:151], v[40:43]
    v_fmac_f32 v176, v104, v244
    v_fmac_f32 v177, v105, v245
    v_fmac_f32_e64 v178, v106, v246
    v_mfma_f32_16x16x32_bf16 v[44:47], a[188:191], v[148:151], v[44:47]
    v_fmac_f32_e64 v179, v107, v247
    v_cvt_pk_bf16_f32 v176, v176, v177
    v_cvt_pk_bf16_f32 v177, v178, v179
    s_mov_b32 s7, 0
    s_waitcnt vmcnt(1)
    v_mfma_f32_16x16x32_bf16 v[32:35], a[192:195], v[152:155], v[32:35]
    buffer_store_dwordx2 v[176:177], v64, s[60:63], s7 offen
    s_waitcnt lgkmcnt(2)
    v_lshlrev_b32 v248, 16, v98
    v_and_b32 v249, 0xffff0000, v98
    v_mfma_f32_16x16x32_bf16 v[36:39], a[196:199], v[152:155], v[36:39]
    v_lshlrev_b32_e64 v250, 16, v99
    v_and_b32 v251, 0xffff0000, v99
    v_fmac_f32 v180, v108, v248
    v_fmac_f32 v181, v109, v249
    v_mfma_f32_16x16x32_bf16 v[40:43], a[200:203], v[152:155], v[40:43]
    v_fmac_f32 v182, v110, v250
    v_fmac_f32 v183, v111, v251
    v_cvt_pk_bf16_f32 v180, v180, v181
    v_cvt_pk_bf16_f32 v181, v182, v183
    v_mfma_f32_16x16x32_bf16 v[44:47], a[204:207], v[152:155], v[44:47]
    s_mov_b32 s7, 16384
    buffer_store_dwordx2 v[180:181], v64, s[60:63], s7 offen
    s_waitcnt lgkmcnt(1)
    v_lshlrev_b32 v244, 16, v100
    s_waitcnt vmcnt(2)
    v_mfma_f32_16x16x32_bf16 v[32:35], a[208:211], v[156:159], v[32:35]
    v_and_b32 v245, 0xffff0000, v100
    v_lshlrev_b32 v246, 16, v101
    v_and_b32 v247, 0xffff0000, v101
    v_fmac_f32_e64 v184, v112, v244
    v_mfma_f32_16x16x32_bf16 v[36:39], a[212:215], v[156:159], v[36:39]
    v_fmac_f32 v185, v113, v245
    v_fmac_f32 v186, v114, v246
    v_fmac_f32_e64 v187, v115, v247
    v_cvt_pk_bf16_f32 v184, v184, v185
    v_mfma_f32_16x16x32_bf16 v[40:43], a[216:219], v[156:159], v[40:43]
    v_cvt_pk_bf16_f32 v185, v186, v187
    s_mov_b32 s7, 32768
    buffer_store_dwordx2 v[184:185], v64, s[60:63], s7 offen
    v_mfma_f32_16x16x32_bf16 v[44:47], a[220:223], v[156:159], v[44:47]
    s_waitcnt lgkmcnt(0)
    v_lshlrev_b32 v252, 16, v102
    v_and_b32 v253, 0xffff0000, v102
    v_lshlrev_b32_e64 v254, 16, v103
    v_and_b32 v255, 0xffff0000, v103
    ds_write_b128 v121, v[32:35] offset:16384
    ds_write_b128 v121, v[36:39] offset:20480
    ds_write_b128 v121, v[40:43] offset:24576
    ds_write_b128 v121, v[44:47] offset:28672
    s_waitcnt lgkmcnt(0)
    s_barrier
    ds_read_b128 v[192:195], v123 offset:16384
    ds_read_b128 v[196:199], v123 offset:17408
    ds_read_b128 v[200:203], v123 offset:18432
    ds_read_b128 v[204:207], v123 offset:19456
    s_waitcnt lgkmcnt(2)
    v_pk_add_f32 v[192:193], v[192:193], v[196:197]
    v_pk_add_f32 v[194:195], v[194:195], v[198:199]
    s_waitcnt lgkmcnt(0)
    v_pk_add_f32 v[200:201], v[200:201], v[204:205]
    v_pk_add_f32 v[202:203], v[202:203], v[206:207]
    v_pk_add_f32 v[208:209], v[192:193], v[200:201]
    v_pk_add_f32 v[210:211], v[194:195], v[202:203]
    v_mul_f32 v240, 0xbfb8aa3b, v208
    v_mul_f32 v241, 0xbfb8aa3b, v209
    v_mul_f32 v242, 0xbfb8aa3b, v210
    v_mul_f32 v243, 0xbfb8aa3b, v211
    v_exp_f32 v240, v240
    v_exp_f32 v241, v241
    v_exp_f32 v242, v242
    v_exp_f32 v243, v243
    v_mul_f32 v116, v116, v208
    v_mul_f32 v117, v117, v209
    v_mul_f32 v118, v118, v210
    v_mul_f32 v119, v119, v211
    v_add_f32 v240, 1.0, v240
    v_add_f32 v241, 1.0, v241
    v_add_f32 v242, 1.0, v242
    v_add_f32 v243, 1.0, v243
    v_rcp_f32 v240, v240
    v_rcp_f32 v241, v241
    v_rcp_f32 v242, v242
    v_rcp_f32 v243, v243
    v_mul_f32 v116, v116, v240
    v_mul_f32 v117, v117, v241
    v_mul_f32 v118, v118, v242
    v_mul_f32 v119, v119, v243
    v_fmac_f32 v188, v116, v252
    v_fmac_f32 v189, v117, v253
    v_fmac_f32 v190, v118, v254
    v_fmac_f32 v191, v119, v255
    v_cvt_pk_bf16_f32 v188, v188, v189
    v_cvt_pk_bf16_f32 v189, v190, v191
    s_mov_b32 s7, 49152
    buffer_store_dwordx2 v[188:189], v64, s[60:63], s7 offen
L_end:
    s_endpgm
L_sf_slow:
    s_mov_b32 s78, 0
L_sf_spin:
    s_sleep 8
    buffer_load_dword v21, v20, s[64:67], 0 offen sc1
    s_waitcnt vmcnt(0)
    v_cmp_ne_u32 vcc, s21, v21
    s_add_u32 s78, s78, 1
    s_cmp_ge_u32 s78, 0x40000
    s_cbranch_scc1 L_sf_ok
    s_cbranch_vccnz L_sf_spin
    s_branch L_sf_ok
L_wf_slow:
    s_mov_b32 s78, 0
L_wf_spin:
    s_sleep 8
    buffer_load_dword v73, v72, s[64:67], 0 offen sc1
    s_waitcnt vmcnt(0)
    v_cmp_ne_u32 vcc, s21, v73
    s_add_u32 s78, s78, 1
    s_cmp_ge_u32 s78, 0x40000
    s_cbranch_scc1 L_wf_ok
    s_cbranch_vccnz L_wf_spin
    s_branch L_wf_ok
L_pf_slow:
    s_mov_b32 s78, 0
L_pf_spin:
    s_sleep 8
    buffer_load_dword v127, v83, s[64:67], 0 offen sc1
    s_waitcnt vmcnt(0)
    v_cmp_ne_u32 vcc, s21, v127
    s_add_u32 s78, s78, 1
    s_cmp_ge_u32 s78, 0x40000
    s_cbranch_scc1 L_pf_ok
    s_cbranch_vccnz L_pf_spin
    s_branch L_pf_ok
L_hf_slow:
    s_mov_b32 s78, 0
L_hf_spin:
    s_sleep 8
    buffer_load_dword v126, v82, s[64:67], 0 offen sc1
    s_waitcnt vmcnt(0)
    v_cmp_ne_u32 vcc, s21, v126
    s_add_u32 s78, s78, 1
    s_cmp_ge_u32 s78, 0x40000
    s_cbranch_scc1 L_hf_ok
    s_cbranch_vccnz L_hf_spin
    s_branch L_hf_ok
L_hb_slow:
    s_mov_b32 s78, 0
L_hb_spin:
    s_sleep 8
    buffer_load_dword v126, v82, s[64:67], 0 offen sc1
    s_waitcnt vmcnt(0)
    v_cmp_ne_u32 vcc, s21, v126
    s_add_u32 s78, s78, 1
    s_cmp_ge_u32 s78, 0x40000
    s_cbranch_scc1 L_hb_ok
    s_cbranch_vccnz L_hb_spin
    s_branch L_hb_ok
L_yf_slow:
    s_mov_b32 s78, 0
L_yf_spin:
    s_sleep 8
    buffer_load_dword v127, v81, s[64:67], 0 offen sc1
    s_waitcnt vmcnt(0)
    v_cmp_ne_u32 vcc, s21, v127
    s_add_u32 s78, s78, 1
    s_cmp_ge_u32 s78, 0x40000
    s_cbranch_scc1 L_yf_ok
    s_cbranch_vccnz L_yf_spin
    s_branch L_yf_ok
L_wfs_slow:
    s_mov_b32 s78, 0
L_wfs_spin:
    s_sleep 8
    buffer_load_dword v23, v22, s[64:67], 0 offen sc1
    s_waitcnt vmcnt(0)
    v_cmp_ne_u32 vcc, s21, v23
    s_add_u32 s78, s78, 1
    s_cmp_ge_u32 s78, 0x40000
    s_cbranch_scc1 L_wfs_ok
    s_cbranch_vccnz L_wfs_spin
    s_branch L_wfs_ok
L_pfs_slow:
    s_mov_b32 s78, 0
L_pfs_spin:
    s_sleep 8
    buffer_load_dword v127, v83, s[64:67], 0 offen sc1
    s_waitcnt vmcnt(0)
    v_cmp_ne_u32 vcc, s21, v127
    s_add_u32 s78, s78, 1
    s_cmp_ge_u32 s78, 0x40000
    s_cbranch_scc1 L_pfs_ok
    s_cbranch_vccnz L_pfs_spin
    s_branch L_pfs_ok
L_ep0_slow:
    s_mov_b32 s78, 0
L_ep0_spin:
    s_sleep 8
    buffer_load_dword v127, v126, s[64:67], 0 offen sc1
    s_waitcnt vmcnt(0)
    v_cmp_ne_u32 vcc, s6, v127
    s_add_u32 s78, s78, 1
    s_cmp_ge_u32 s78, 0x40000
    s_cbranch_scc1 L_ep0_ok
    s_cbranch_vccnz L_ep0_spin
    s_branch L_ep0_ok
L_ep1_slow:
    s_mov_b32 s78, 0
L_ep1_spin:
    s_sleep 8
    buffer_load_dword v127, v126, s[64:67], 0 offen sc1
    s_waitcnt vmcnt(0)
    v_cmp_ne_u32 vcc, s6, v127
    s_add_u32 s78, s78, 1
    s_cmp_ge_u32 s78, 0x40000
    s_cbranch_scc1 L_ep1_ok
    s_cbranch_vccnz L_ep1_spin
    s_branch L_ep1_ok
L_ep2_slow:
    s_mov_b32 s78, 0
L_ep2_spin:
    s_sleep 8
    buffer_load_dword v127, v126, s[64:67], 0 offen sc1
    s_waitcnt vmcnt(0)
    v_cmp_ne_u32 vcc, s6, v127
    s_add_u32 s78, s78, 1
    s_cmp_ge_u32 s78, 0x40000
    s_cbranch_scc1 L_ep2_ok
    s_cbranch_vccnz L_ep2_spin
    s_branch L_ep2_ok
L_ep3_slow:
    s_mov_b32 s78, 0
L_ep3_spin:
    s_sleep 8
    buffer_load_dword v127, v126, s[64:67], 0 offen sc1
    s_waitcnt vmcnt(0)
    v_cmp_ne_u32 vcc, s6, v127
    s_add_u32 s78, s78, 1
    s_cmp_ge_u32 s78, 0x40000
    s_cbranch_scc1 L_ep3_ok
    s_cbranch_vccnz L_ep3_spin
    s_branch L_ep3_ok
L_srole:
    s_mov_b32 s40, s10
    s_mov_b32 s41, s11
    s_mov_b32 s42, 2097152
    s_mov_b32 s43, 0x20000
    s_mov_b32 s44, s12
    s_mov_b32 s45, s13
    s_mov_b32 s46, 2097152
    s_mov_b32 s47, 0x20000
    s_sub_u32 s68, s5, 28
    v_lshrrev_b32 v9, 1, v6
    v_and_b32 v10, 1, v3
    v_lshlrev_b32 v10, 1, v10
    v_xor_b32 v9, v9, v10
    v_lshlrev_b32 v9, 5, v9
    v_and_b32 v10, 1, v6
    v_lshl_add_u32 v9, v10, 4, v9
    v_lshl_add_u32 v9, v5, 10, v9
    s_lshl_b32 s97, s4, 2
    s_add_u32 s97, s97, s68
    s_and_b32 s70, s97, 1
    s_lshl_b32 s70, s70, 2
    s_add_u32 s70, s70, s3
    s_lshl_b32 s7, s70, 7
    v_add_u32 v84, s7, v9
    s_lshr_b32 s74, s97, 1
    s_lshl_b32 s83, s74, 17
    s_sub_u32 s77, s83, 8192
    s_cmp_eq_u32 s74, 0
    s_cselect_b32 s77, 0x80000000, s77
    v_add_u32_e64 v86, s77, v84
    s_mul_i32 s80, s3, 40960
    s_mov_b32 m0, s80
    s_mov_b32 s81, 0xffff
    s_lshl_b32 s74, s70, 9
    v_lshl_add_u32 v13, v1, 3, s74
    global_load_dwordx2 v[96:97], v13, s[14:15]
    buffer_load_dwordx4 v86, s[40:43], 0 offen  lds
    s_add_u32 m0, s80, 1024
    s_add_u32 s76, s83, 0
    s_nop 0
    buffer_load_dwordx4 v84, s[40:43], s76 offen  lds
    s_add_u32 m0, s80, 2048
    s_add_u32 s76, s83, 8192
    buffer_load_dwordx4 v84, s[40:43], s76 offen  lds
    s_add_u32 m0, s80, 17408
    s_add_u32 s76, s83, 0
    s_nop 0
    buffer_load_dwordx4 v84, s[44:47], s76 offen  lds
    s_add_u32 m0, s80, 18432
    s_add_u32 s76, s83, 8192
    buffer_load_dwordx4 v84, s[44:47], s76 offen  lds
    s_add_u32 m0, s80, 3072
    s_add_u32 s76, s83, 16384
    buffer_load_dwordx4 v84, s[40:43], s76 offen  lds
    s_add_u32 m0, s80, 4096
    s_add_u32 s76, s83, 24576
    buffer_load_dwordx4 v84, s[40:43], s76 offen  lds
    s_add_u32 m0, s80, 19456
    s_add_u32 s76, s83, 16384
    buffer_load_dwordx4 v84, s[44:47], s76 offen  lds
    s_add_u32 m0, s80, 20480
    s_add_u32 s76, s83, 24576
    buffer_load_dwordx4 v84, s[44:47], s76 offen  lds
    s_getpc_b64 s[34:35]
L_pcs:
    s_sub_u32 s34, s34, L_pcs-recurrent_scan__ssm_conv_h3__swiglu_ffn__prompt_kernel
    s_subb_u32 s35, s35, 0
    s_lshl_b32 s7, s5, 2
    s_add_u32 s7, s7, s3
    s_mul_i32 s7, s7, 384
    v_min_u32_e64 v18, 2, v1
    v_lshl_add_u32 v18, v18, 7, s7
    v_min_u32 v18, L_codeend-recurrent_scan__ssm_conv_h3__swiglu_ffn__prompt_kernel-4, v18
    global_load_dword v18, v18, s[34:35]
    s_lshl_b32 s73, s4, 6
    s_lshl_b32 s7, s5, 1
    s_add_u32 s73, s73, s7
    s_lshr_b32 s7, s3, 1
    s_add_u32 s73, s73, s7
    s_lshl_b32 s74, s73, 12
    s_load_dwordx2 s[100:101], s[16:17], s74
    s_lshr_b32 s7, s73, 1
    s_lshl_b32 s7, s7, 2
    s_load_dword s85, s[18:19], s7
    s_mov_b32 s52, s16
    s_mov_b32 s53, s17
    s_mov_b32 s54, 2097152
    s_mov_b32 s55, 0x20000
    s_mov_b32 s60, s28
    s_mov_b32 s61, s29
    s_mov_b32 s62, 2097152
    s_mov_b32 s63, 0x20000
    s_lshl_b32 s71, s4, 2
    s_and_b32 s74, s5, 3
    s_add_u32 s71, s71, s74
    s_lshr_b32 s7, s3, 1
    s_mul_i32 s10, s7, 21760
    s_add_u32 s10, s10, 98304
    s_lshl_b32 s74, s73, 12
    s_and_b32 s75, s3, 1
    s_lshl_b32 s75, s75, 11
    s_add_u32 s31, s75, s74
    s_mul_i32 s74, s73, 4224
    s_add_u32 s96, s75, s74
    s_lshl_b32 s95, s4, 12
    s_lshl_b32 s74, s5, 7
    s_add_u32 s95, s95, s74
    s_add_u32 s95, s95, 32768
    v_lshlrev_b32_e64 v104, 7, v7
    v_lshl_add_u32 v104, v8, 3, v104
    v_and_b32 v105, 2, v7
    v_xor_b32 v105, v105, v3
    v_lshl_add_u32 v104, v105, 5, v104
    v_add_u32_e64 v104, s80, v104
    s_add_u32 s7, s80, 25600
    v_mul_u32_u24 v105, 144, v1
    v_add_u32_e64 v105, s7, v105
    v_mul_u32_u24 v106, 144, v5
    v_lshl_add_u32 v106, v6, 4, v106
    v_add_u32_e64 v106, s7, v106
    v_mul_u32_u24 v107, 4224, v5
    v_lshl_add_u32 v107, v6, 4, v107
    s_mul_i32 s7, s70, 270336
    s_lshr_b32 s74, s83, 9
    s_sub_u32 s7, s7, s74
    s_add_u32 s69, s7, 1052544
    v_mov_b32 v12, 0x3f803f80
    s_waitcnt vmcnt(13)
    v_dot2_f32_bf16 v28, v20, v12, 0
    v_dot2_f32_bf16 v30, v20, v20, 0
    s_waitcnt vmcnt(12)
    v_dot2_f32_bf16 v29, v24, v12, 0
    v_dot2_f32_bf16 v31, v24, v24, 0
    v_dot2_f32_bf16 v28, v21, v12, v28
    v_dot2_f32_bf16 v30, v21, v21, v30
    v_dot2_f32_bf16 v29, v25, v12, v29
    v_dot2_f32_bf16 v31, v25, v25, v31
    v_dot2_f32_bf16 v28, v22, v12, v28
    v_dot2_f32_bf16 v30, v22, v22, v30
    v_dot2_f32_bf16 v29, v26, v12, v29
    v_dot2_f32_bf16 v31, v26, v26, v31
    v_dot2_f32_bf16 v28, v23, v12, v28
    v_dot2_f32_bf16 v30, v23, v23, v30
    v_dot2_f32_bf16 v29, v27, v12, v29
    v_dot2_f32_bf16 v31, v27, v27, v31
    s_waitcnt vmcnt(11)
    v_readfirstlane_b32 s6, v17
    v_lshrrev_b32 v13, 5, v1
    v_add_u32 v13, s84, v13
    v_permlane32_swap_b32 v28, v29
    v_permlane32_swap_b32 v30, v31
    s_add_u32 s6, s6, 1
    s_cmp_eq_u32 s3, 0
    s_cselect_b32 s20, 0, 0x80000000
    s_cselect_b32 s21, s6, 0
    v_add_f32 v28, v28, v29
    v_add_f32 v30, v30, v31
    v_lshlrev_b32 v13, 3, v13
    v_mov_b32 v29, v28
    v_mov_b32 v31, v30
    v_add_u32 v13, 262144, v13
    v_and_b32 v14, 31, v1
    v_permlane16_swap_b32 v28, v29
    v_permlane16_swap_b32 v30, v31
    v_cmp_eq_u32 vcc, 0, v14
    v_add_f32 v28, v28, v29
    v_add_f32 v30, v30, v31
    v_mov_b32 v14, 0x80000000
    v_cndmask_b32_e64 v13, v14, v13, vcc
    v_add_f32_dpp v28, v28, v28 row_ror:8 row_mask:0xf bank_mask:0xf
    v_add_f32_dpp v30, v30, v30 row_ror:8 row_mask:0xf bank_mask:0xf
    s_nop 0
    v_add_f32_dpp v28, v28, v28 row_ror:4 row_mask:0xf bank_mask:0xf
    v_add_f32_dpp v30, v30, v30 row_ror:4 row_mask:0xf bank_mask:0xf
    s_nop 0
    v_add_f32_dpp v28, v28, v28 row_ror:2 row_mask:0xf bank_mask:0xf
    v_add_f32_dpp v30, v30, v30 row_ror:2 row_mask:0xf bank_mask:0xf
    s_nop 0
    s_nop 0
    v_add_f32_dpp v28, v28, v28 row_ror:1 row_mask:0xf bank_mask:0xf
    v_add_f32_dpp v30, v30, v30 row_ror:1 row_mask:0xf bank_mask:0xf
    v_mul_f32 v28, 0x3b000000, v28
    v_mul_f32 v30, 0x3b000000, v30
    v_fma_f32 v29, -v28, v28, v30
    v_max_f32_e64 v29, 0, v29
    v_add_f32 v29, 0x3727c5ac, v29
    buffer_store_dwordx2 v[28:29], v13, s[64:67], 0 offen sc1
    s_waitcnt vmcnt(11)
    s_nop 0
    v_alignbit_b32 v108, v96, v96, 16
    v_alignbit_b32 v109, v97, v97, 16
    v_and_b32 v110, 0xffff, v96
    v_bfi_b32 v111, s81, v97, v96
    v_and_b32 v112, 0xffff0000, v97
    s_add_u32 m0, s80, 5120
    s_add_u32 s76, s83, 32768
    buffer_load_dwordx4 v84, s[40:43], s76 offen  lds
    s_add_u32 m0, s80, 6144
    s_add_u32 s76, s83, 40960
    buffer_load_dwordx4 v84, s[40:43], s76 offen  lds
    s_add_u32 m0, s80, 21504
    s_add_u32 s76, s83, 32768
    buffer_load_dwordx4 v84, s[44:47], s76 offen  lds
    s_add_u32 m0, s80, 22528
    s_add_u32 s76, s83, 40960
    buffer_load_dwordx4 v84, s[44:47], s76 offen  lds
    s_waitcnt vmcnt(10)
    s_nop 0
    ds_read_b64_tr_b16 v[128:129], v104 offset:512
    ds_read_b64_tr_b16 v[130:131], v104 offset:1024
    ds_read_b64_tr_b16 v[132:133], v104 offset:1536
    ds_read_b64_tr_b16 v[134:135], v104 offset:2048
    ds_read_b64_tr_b16 v[136:137], v104 offset:2560
    ds_read_b64_tr_b16 v[138:139], v104 offset:17408
    ds_read_b64_tr_b16 v[140:141], v104 offset:17920
    ds_read_b64_tr_b16 v[142:143], v104 offset:18432
    ds_read_b64_tr_b16 v[144:145], v104 offset:18944
    s_waitcnt lgkmcnt(7)
    s_nop 0
    v_dot2_f32_bf16 v33, v130, v108, 0
    s_add_u32 m0, s80, 7168
    s_add_u32 s76, s83, 49152
    buffer_load_dwordx4 v84, s[40:43], s76 offen  lds
    v_dot2_f32_bf16 v32, v130, v110, 0
    v_dot2_f32_bf16 v35, v131, v108, 0
    v_dot2_f32_bf16 v34, v131, v110, 0
    s_waitcnt lgkmcnt(6)
    s_nop 0
    v_dot2_f32_bf16 v37, v132, v108, 0
    v_dot2_f32_bf16 v36, v132, v110, 0
    v_dot2_f32_bf16 v39, v133, v108, 0
    v_dot2_f32_bf16 v38, v133, v110, 0
    s_add_u32 m0, s80, 8192
    s_add_u32 s76, s83, 57344
    buffer_load_dwordx4 v84, s[40:43], s76 offen  lds
    s_waitcnt lgkmcnt(5)
    s_nop 0
    v_dot2_f32_bf16 v41, v134, v108, 0
    v_dot2_f32_bf16 v40, v134, v110, 0
    v_dot2_f32_bf16 v43, v135, v108, 0
    v_dot2_f32_bf16 v42, v135, v110, 0
    s_waitcnt lgkmcnt(4)
    s_nop 0
    v_dot2_f32_bf16 v45, v136, v108, 0
    v_dot2_f32_bf16 v44, v136, v110, 0
    v_dot2_f32_bf16 v47, v137, v108, 0
    s_add_u32 m0, s80, 23552
    s_add_u32 s76, s83, 49152
    buffer_load_dwordx4 v84, s[44:47], s76 offen  lds
    v_dot2_f32_bf16 v46, v137, v110, 0
    v_dot2_f32_bf16 v33, v129, v109, v33
    v_dot2_f32_bf16 v32, v129, v111, v32
    v_dot2_f32_bf16 v35, v130, v109, v35
    v_dot2_f32_bf16 v34, v130, v111, v34
    v_dot2_f32_bf16 v37, v131, v109, v37
    v_dot2_f32_bf16 v36, v131, v111, v36
    s_add_u32 m0, s80, 24576
    s_add_u32 s76, s83, 57344
    buffer_load_dwordx4 v84, s[44:47], s76 offen  lds
    v_dot2_f32_bf16 v39, v132, v109, v39
    v_dot2_f32_bf16 v38, v132, v111, v38
    v_dot2_f32_bf16 v41, v133, v109, v41
    v_dot2_f32_bf16 v40, v133, v111, v40
    v_dot2_f32_bf16 v43, v134, v109, v43
    v_dot2_f32_bf16 v42, v134, v111, v42
    v_dot2_f32_bf16 v45, v135, v109, v45
    v_dot2_f32_bf16 v44, v135, v111, v44
    v_dot2_f32_bf16 v47, v136, v109, v47
    s_waitcnt vmcnt(10)
    s_nop 0
    ds_read_b64_tr_b16 v[148:149], v104 offset:2560
    ds_read_b64_tr_b16 v[150:151], v104 offset:3072
    ds_read_b64_tr_b16 v[152:153], v104 offset:3584
    ds_read_b64_tr_b16 v[154:155], v104 offset:4096
    ds_read_b64_tr_b16 v[156:157], v104 offset:4608
    ds_read_b64_tr_b16 v[158:159], v104 offset:19456
    ds_read_b64_tr_b16 v[160:161], v104 offset:19968
    ds_read_b64_tr_b16 v[162:163], v104 offset:20480
    ds_read_b64_tr_b16 v[164:165], v104 offset:20992
    v_dot2_f32_bf16 v46, v136, v111, v46
    v_dot2_f32_bf16 v32, v128, v112, v32
    v_dot2_f32_bf16 v34, v129, v112, v34
    v_dot2_f32_bf16 v36, v130, v112, v36
    v_dot2_f32_bf16 v38, v131, v112, v38
    v_dot2_f32_bf16 v40, v132, v112, v40
    v_dot2_f32_bf16 v42, v133, v112, v42
    v_dot2_f32_bf16 v44, v134, v112, v44
    v_dot2_f32_bf16 v46, v135, v112, v46
    s_waitcnt lgkmcnt(12)
    v_lshlrev_b32 v48, 16, v138
    v_and_b32 v49, 0xffff0000, v138
    v_lshlrev_b32_e64 v50, 16, v139
    v_and_b32 v51, 0xffff0000, v139
    s_waitcnt lgkmcnt(11)
    v_lshlrev_b32 v52, 16, v140
    v_and_b32 v53, 0xffff0000, v140
    v_lshlrev_b32_e64 v54, 16, v141
    v_and_b32 v55, 0xffff0000, v141
    s_waitcnt lgkmcnt(10)
    v_lshlrev_b32 v56, 16, v142
    v_and_b32 v57, 0xffff0000, v142
    v_lshlrev_b32_e64 v58, 16, v143
    v_and_b32 v59, 0xffff0000, v143
    s_waitcnt lgkmcnt(9)
    v_lshlrev_b32 v60, 16, v144
    v_and_b32 v61, 0xffff0000, v144
    v_lshlrev_b32_e64 v62, 16, v145
    v_and_b32 v63, 0xffff0000, v145
    v_pk_mul_f32 v[32:33], v[32:33], v[48:49]
    v_pk_mul_f32 v[34:35], v[34:35], v[50:51]
    v_pk_mul_f32 v[36:37], v[36:37], v[52:53]
    v_pk_mul_f32 v[38:39], v[38:39], v[54:55]
    v_pk_mul_f32 v[40:41], v[40:41], v[56:57]
    v_pk_mul_f32 v[42:43], v[42:43], v[58:59]
    v_pk_mul_f32 v[44:45], v[44:45], v[60:61]
    v_pk_mul_f32 v[46:47], v[46:47], v[62:63]
    v_cvt_pk_bf16_f32 v64, v47, v46
    v_cvt_pk_bf16_f32 v65, v45, v44
    v_cvt_pk_bf16_f32 v66, v43, v42
    v_cvt_pk_bf16_f32 v67, v41, v40
    v_cvt_pk_bf16_f32 v68, v39, v38
    v_cvt_pk_bf16_f32 v69, v37, v36
    v_cvt_pk_bf16_f32 v70, v35, v34
    v_cvt_pk_bf16_f32 v71, v33, v32
    ds_write_b128 v105, v[64:67] offset:96
    ds_write_b128 v105, v[68:71] offset:112
    s_waitcnt lgkmcnt(9)
    s_nop 0
    v_dot2_f32_bf16 v33, v150, v108, 0
    s_add_u32 m0, s80, 9216
    s_add_u32 s76, s83, 65536
    buffer_load_dwordx4 v84, s[40:43], s76 offen  lds
    v_dot2_f32_bf16 v32, v150, v110, 0
    v_dot2_f32_bf16 v35, v151, v108, 0
    v_dot2_f32_bf16 v34, v151, v110, 0
    s_waitcnt lgkmcnt(8)
    s_nop 0
    v_dot2_f32_bf16 v37, v152, v108, 0
    v_dot2_f32_bf16 v36, v152, v110, 0
    v_dot2_f32_bf16 v39, v153, v108, 0
    v_dot2_f32_bf16 v38, v153, v110, 0
    s_add_u32 m0, s80, 10240
    s_add_u32 s76, s83, 73728
    buffer_load_dwordx4 v84, s[40:43], s76 offen  lds
    s_waitcnt lgkmcnt(7)
    s_nop 0
    v_dot2_f32_bf16 v41, v154, v108, 0
    v_dot2_f32_bf16 v40, v154, v110, 0
    v_dot2_f32_bf16 v43, v155, v108, 0
    v_dot2_f32_bf16 v42, v155, v110, 0
    s_waitcnt lgkmcnt(6)
    s_nop 0
    v_dot2_f32_bf16 v45, v156, v108, 0
    v_dot2_f32_bf16 v44, v156, v110, 0
    v_dot2_f32_bf16 v47, v157, v108, 0
    s_add_u32 m0, s80, 17408
    s_add_u32 s76, s83, 65536
    buffer_load_dwordx4 v84, s[44:47], s76 offen  lds
    v_dot2_f32_bf16 v46, v157, v110, 0
    v_dot2_f32_bf16 v33, v149, v109, v33
    v_dot2_f32_bf16 v32, v149, v111, v32
    v_dot2_f32_bf16 v35, v150, v109, v35
    v_dot2_f32_bf16 v34, v150, v111, v34
    v_dot2_f32_bf16 v37, v151, v109, v37
    v_dot2_f32_bf16 v36, v151, v111, v36
    s_add_u32 m0, s80, 18432
    s_add_u32 s76, s83, 73728
    buffer_load_dwordx4 v84, s[44:47], s76 offen  lds
    v_dot2_f32_bf16 v39, v152, v109, v39
    v_dot2_f32_bf16 v38, v152, v111, v38
    v_dot2_f32_bf16 v41, v153, v109, v41
    v_dot2_f32_bf16 v40, v153, v111, v40
    v_dot2_f32_bf16 v43, v154, v109, v43
    v_dot2_f32_bf16 v42, v154, v111, v42
    v_dot2_f32_bf16 v45, v155, v109, v45
    v_dot2_f32_bf16 v44, v155, v111, v44
    v_dot2_f32_bf16 v47, v156, v109, v47
    s_waitcnt vmcnt(8)
    s_nop 0
    ds_read_b64_tr_b16 v[128:129], v104 offset:4608
    ds_read_b64_tr_b16 v[130:131], v104 offset:5120
    ds_read_b64_tr_b16 v[132:133], v104 offset:5632
    ds_read_b64_tr_b16 v[134:135], v104 offset:6144
    ds_read_b64_tr_b16 v[136:137], v104 offset:6656
    ds_read_b64_tr_b16 v[138:139], v104 offset:21504
    ds_read_b64_tr_b16 v[140:141], v104 offset:22016
    ds_read_b64_tr_b16 v[142:143], v104 offset:22528
    ds_read_b64_tr_b16 v[144:145], v104 offset:23040
    v_dot2_f32_bf16 v46, v156, v111, v46
    v_dot2_f32_bf16 v32, v148, v112, v32
    v_dot2_f32_bf16 v34, v149, v112, v34
    v_dot2_f32_bf16 v36, v150, v112, v36
    v_dot2_f32_bf16 v38, v151, v112, v38
    v_dot2_f32_bf16 v40, v152, v112, v40
    v_dot2_f32_bf16 v42, v153, v112, v42
    v_dot2_f32_bf16 v44, v154, v112, v44
    v_dot2_f32_bf16 v46, v155, v112, v46
    s_waitcnt lgkmcnt(14)
    v_lshlrev_b32 v48, 16, v158
    v_and_b32 v49, 0xffff0000, v158
    v_lshlrev_b32_e64 v50, 16, v159
    v_and_b32 v51, 0xffff0000, v159
    s_waitcnt lgkmcnt(13)
    v_lshlrev_b32 v52, 16, v160
    v_and_b32 v53, 0xffff0000, v160
    v_lshlrev_b32_e64 v54, 16, v161
    v_and_b32 v55, 0xffff0000, v161
    s_waitcnt lgkmcnt(12)
    v_lshlrev_b32 v56, 16, v162
    v_and_b32 v57, 0xffff0000, v162
    v_lshlrev_b32_e64 v58, 16, v163
    v_and_b32 v59, 0xffff0000, v163
    s_waitcnt lgkmcnt(11)
    v_lshlrev_b32 v60, 16, v164
    v_and_b32 v61, 0xffff0000, v164
    v_lshlrev_b32_e64 v62, 16, v165
    v_and_b32 v63, 0xffff0000, v165
    v_pk_mul_f32 v[32:33], v[32:33], v[48:49]
    v_pk_mul_f32 v[34:35], v[34:35], v[50:51]
    v_pk_mul_f32 v[36:37], v[36:37], v[52:53]
    v_pk_mul_f32 v[38:39], v[38:39], v[54:55]
    v_pk_mul_f32 v[40:41], v[40:41], v[56:57]
    v_pk_mul_f32 v[42:43], v[42:43], v[58:59]
    v_pk_mul_f32 v[44:45], v[44:45], v[60:61]
    v_pk_mul_f32 v[46:47], v[46:47], v[62:63]
    v_cvt_pk_bf16_f32 v64, v47, v46
    v_cvt_pk_bf16_f32 v65, v45, v44
    v_cvt_pk_bf16_f32 v66, v43, v42
    v_cvt_pk_bf16_f32 v67, v41, v40
    v_cvt_pk_bf16_f32 v68, v39, v38
    v_cvt_pk_bf16_f32 v69, v37, v36
    v_cvt_pk_bf16_f32 v70, v35, v34
    v_cvt_pk_bf16_f32 v71, v33, v32
    ds_write_b128 v105, v[64:67] offset:64
    ds_write_b128 v105, v[68:71] offset:80
    s_barrier
    s_or_b32 s78, s95, s20
    v_mov_b32 v10, s78
    v_mov_b32 v11, s6
    s_mov_b64 exec, 1
    buffer_store_dword v11, v10, s[64:67], 0 offen sc1
    s_mov_b64 exec, -1
    s_waitcnt lgkmcnt(9)
    s_nop 0
    v_dot2_f32_bf16 v33, v130, v108, 0
    s_add_u32 m0, s80, 11264
    s_add_u32 s76, s83, 81920
    buffer_load_dwordx4 v84, s[40:43], s76 offen  lds
    v_dot2_f32_bf16 v32, v130, v110, 0
    v_dot2_f32_bf16 v35, v131, v108, 0
    v_dot2_f32_bf16 v34, v131, v110, 0
    s_waitcnt lgkmcnt(8)
    s_nop 0
    v_dot2_f32_bf16 v37, v132, v108, 0
    v_dot2_f32_bf16 v36, v132, v110, 0
    v_dot2_f32_bf16 v39, v133, v108, 0
    v_dot2_f32_bf16 v38, v133, v110, 0
    s_add_u32 m0, s80, 12288
    s_add_u32 s76, s83, 90112
    buffer_load_dwordx4 v84, s[40:43], s76 offen  lds
    s_waitcnt lgkmcnt(7)
    s_nop 0
    v_dot2_f32_bf16 v41, v134, v108, 0
    v_dot2_f32_bf16 v40, v134, v110, 0
    v_dot2_f32_bf16 v43, v135, v108, 0
    v_dot2_f32_bf16 v42, v135, v110, 0
    s_waitcnt lgkmcnt(6)
    s_nop 0
    v_dot2_f32_bf16 v45, v136, v108, 0
    v_dot2_f32_bf16 v44, v136, v110, 0
    v_dot2_f32_bf16 v47, v137, v108, 0
    s_add_u32 m0, s80, 19456
    s_add_u32 s76, s83, 81920
    buffer_load_dwordx4 v84, s[44:47], s76 offen  lds
    v_dot2_f32_bf16 v46, v137, v110, 0
    v_dot2_f32_bf16 v33, v129, v109, v33
    v_dot2_f32_bf16 v32, v129, v111, v32
    v_dot2_f32_bf16 v35, v130, v109, v35
    v_dot2_f32_bf16 v34, v130, v111, v34
    v_dot2_f32_bf16 v37, v131, v109, v37
    v_dot2_f32_bf16 v36, v131, v111, v36
    s_add_u32 m0, s80, 20480
    s_add_u32 s76, s83, 90112
    buffer_load_dwordx4 v84, s[44:47], s76 offen  lds
    v_dot2_f32_bf16 v39, v132, v109, v39
    v_dot2_f32_bf16 v38, v132, v111, v38
    v_dot2_f32_bf16 v41, v133, v109, v41
    v_dot2_f32_bf16 v40, v133, v111, v40
    v_dot2_f32_bf16 v43, v134, v109, v43
    v_dot2_f32_bf16 v42, v134, v111, v42
    v_dot2_f32_bf16 v45, v135, v109, v45
    v_dot2_f32_bf16 v44, v135, v111, v44
    v_dot2_f32_bf16 v47, v136, v109, v47
    s_waitcnt vmcnt(9)
    s_nop 0
    ds_read_b64_tr_b16 v[148:149], v104 offset:6656
    ds_read_b64_tr_b16 v[150:151], v104 offset:7168
    ds_read_b64_tr_b16 v[152:153], v104 offset:7680
    ds_read_b64_tr_b16 v[154:155], v104 offset:8192
    ds_read_b64_tr_b16 v[156:157], v104 offset:8704
    ds_read_b64_tr_b16 v[158:159], v104 offset:23552
    ds_read_b64_tr_b16 v[160:161], v104 offset:24064
    ds_read_b64_tr_b16 v[162:163], v104 offset:24576
    ds_read_b64_tr_b16 v[164:165], v104 offset:25088
    v_dot2_f32_bf16 v46, v136, v111, v46
    v_dot2_f32_bf16 v32, v128, v112, v32
    v_dot2_f32_bf16 v34, v129, v112, v34
    v_dot2_f32_bf16 v36, v130, v112, v36
    v_dot2_f32_bf16 v38, v131, v112, v38
    v_dot2_f32_bf16 v40, v132, v112, v40
    v_dot2_f32_bf16 v42, v133, v112, v42
    v_dot2_f32_bf16 v44, v134, v112, v44
    v_dot2_f32_bf16 v46, v135, v112, v46
    s_waitcnt lgkmcnt(14)
    v_lshlrev_b32 v48, 16, v138
    v_and_b32 v49, 0xffff0000, v138
    v_lshlrev_b32_e64 v50, 16, v139
    v_and_b32 v51, 0xffff0000, v139
    s_waitcnt lgkmcnt(13)
    v_lshlrev_b32 v52, 16, v140
    v_and_b32 v53, 0xffff0000, v140
    v_lshlrev_b32_e64 v54, 16, v141
    v_and_b32 v55, 0xffff0000, v141
    s_waitcnt lgkmcnt(12)
    v_lshlrev_b32 v56, 16, v142
    v_and_b32 v57, 0xffff0000, v142
    v_lshlrev_b32_e64 v58, 16, v143
    v_and_b32 v59, 0xffff0000, v143
    s_waitcnt lgkmcnt(11)
    v_lshlrev_b32 v60, 16, v144
    v_and_b32 v61, 0xffff0000, v144
    v_lshlrev_b32_e64 v62, 16, v145
    v_and_b32 v63, 0xffff0000, v145
    v_pk_mul_f32 v[32:33], v[32:33], v[48:49]
    v_pk_mul_f32 v[34:35], v[34:35], v[50:51]
    v_pk_mul_f32 v[36:37], v[36:37], v[52:53]
    v_pk_mul_f32 v[38:39], v[38:39], v[54:55]
    v_pk_mul_f32 v[40:41], v[40:41], v[56:57]
    v_pk_mul_f32 v[42:43], v[42:43], v[58:59]
    v_pk_mul_f32 v[44:45], v[44:45], v[60:61]
    v_pk_mul_f32 v[46:47], v[46:47], v[62:63]
    v_cvt_pk_bf16_f32 v64, v47, v46
    v_cvt_pk_bf16_f32 v65, v45, v44
    v_cvt_pk_bf16_f32 v66, v43, v42
    v_cvt_pk_bf16_f32 v67, v41, v40
    v_cvt_pk_bf16_f32 v68, v39, v38
    v_cvt_pk_bf16_f32 v69, v37, v36
    v_cvt_pk_bf16_f32 v70, v35, v34
    v_cvt_pk_bf16_f32 v71, v33, v32
    ds_write_b128 v105, v[64:67] offset:32
    ds_write_b128 v105, v[68:71] offset:48
    s_waitcnt lgkmcnt(9)
    s_nop 0
    v_dot2_f32_bf16 v33, v150, v108, 0
    s_add_u32 m0, s80, 13312
    s_add_u32 s76, s83, 98304
    buffer_load_dwordx4 v84, s[40:43], s76 offen  lds
    v_dot2_f32_bf16 v32, v150, v110, 0
    v_dot2_f32_bf16 v35, v151, v108, 0
    v_dot2_f32_bf16 v34, v151, v110, 0
    s_waitcnt lgkmcnt(8)
    s_nop 0
    v_dot2_f32_bf16 v37, v152, v108, 0
    v_dot2_f32_bf16 v36, v152, v110, 0
    v_dot2_f32_bf16 v39, v153, v108, 0
    v_dot2_f32_bf16 v38, v153, v110, 0
    s_add_u32 m0, s80, 14336
    s_add_u32 s76, s83, 106496
    buffer_load_dwordx4 v84, s[40:43], s76 offen  lds
    s_waitcnt lgkmcnt(7)
    s_nop 0
    v_dot2_f32_bf16 v41, v154, v108, 0
    v_dot2_f32_bf16 v40, v154, v110, 0
    v_dot2_f32_bf16 v43, v155, v108, 0
    v_dot2_f32_bf16 v42, v155, v110, 0
    s_waitcnt lgkmcnt(6)
    s_nop 0
    v_dot2_f32_bf16 v45, v156, v108, 0
    v_dot2_f32_bf16 v44, v156, v110, 0
    v_dot2_f32_bf16 v47, v157, v108, 0
    s_add_u32 m0, s80, 21504
    s_add_u32 s76, s83, 98304
    buffer_load_dwordx4 v84, s[44:47], s76 offen  lds
    v_dot2_f32_bf16 v46, v157, v110, 0
    v_dot2_f32_bf16 v33, v149, v109, v33
    v_dot2_f32_bf16 v32, v149, v111, v32
    v_dot2_f32_bf16 v35, v150, v109, v35
    v_dot2_f32_bf16 v34, v150, v111, v34
    v_dot2_f32_bf16 v37, v151, v109, v37
    v_dot2_f32_bf16 v36, v151, v111, v36
    s_add_u32 m0, s80, 22528
    s_add_u32 s76, s83, 106496
    buffer_load_dwordx4 v84, s[44:47], s76 offen  lds
    v_dot2_f32_bf16 v39, v152, v109, v39
    v_dot2_f32_bf16 v38, v152, v111, v38
    v_dot2_f32_bf16 v41, v153, v109, v41
    v_dot2_f32_bf16 v40, v153, v111, v40
    v_dot2_f32_bf16 v43, v154, v109, v43
    v_dot2_f32_bf16 v42, v154, v111, v42
    v_dot2_f32_bf16 v45, v155, v109, v45
    v_dot2_f32_bf16 v44, v155, v111, v44
    v_dot2_f32_bf16 v47, v156, v109, v47
    s_waitcnt vmcnt(9)
    s_nop 0
    ds_read_b64_tr_b16 v[128:129], v104 offset:8704
    ds_read_b64_tr_b16 v[130:131], v104 offset:9216
    ds_read_b64_tr_b16 v[132:133], v104 offset:9728
    ds_read_b64_tr_b16 v[134:135], v104 offset:10240
    ds_read_b64_tr_b16 v[136:137], v104 offset:10752
    ds_read_b64_tr_b16 v[138:139], v104 offset:17408
    ds_read_b64_tr_b16 v[140:141], v104 offset:17920
    ds_read_b64_tr_b16 v[142:143], v104 offset:18432
    ds_read_b64_tr_b16 v[144:145], v104 offset:18944
    v_dot2_f32_bf16 v46, v156, v111, v46
    v_dot2_f32_bf16 v32, v148, v112, v32
    v_dot2_f32_bf16 v34, v149, v112, v34
    v_dot2_f32_bf16 v36, v150, v112, v36
    v_dot2_f32_bf16 v38, v151, v112, v38
    v_dot2_f32_bf16 v40, v152, v112, v40
    v_dot2_f32_bf16 v42, v153, v112, v42
    v_dot2_f32_bf16 v44, v154, v112, v44
    v_dot2_f32_bf16 v46, v155, v112, v46
    s_waitcnt lgkmcnt(14)
    v_lshlrev_b32 v48, 16, v158
    v_and_b32 v49, 0xffff0000, v158
    v_lshlrev_b32_e64 v50, 16, v159
    v_and_b32 v51, 0xffff0000, v159
    s_waitcnt lgkmcnt(13)
    v_lshlrev_b32 v52, 16, v160
    v_and_b32 v53, 0xffff0000, v160
    v_lshlrev_b32_e64 v54, 16, v161
    v_and_b32 v55, 0xffff0000, v161
    s_waitcnt lgkmcnt(12)
    v_lshlrev_b32 v56, 16, v162
    v_and_b32 v57, 0xffff0000, v162
    v_lshlrev_b32_e64 v58, 16, v163
    v_and_b32 v59, 0xffff0000, v163
    s_waitcnt lgkmcnt(11)
    v_lshlrev_b32 v60, 16, v164
    v_and_b32 v61, 0xffff0000, v164
    v_lshlrev_b32_e64 v62, 16, v165
    v_and_b32 v63, 0xffff0000, v165
    v_pk_mul_f32 v[32:33], v[32:33], v[48:49]
    v_pk_mul_f32 v[34:35], v[34:35], v[50:51]
    v_pk_mul_f32 v[36:37], v[36:37], v[52:53]
    v_pk_mul_f32 v[38:39], v[38:39], v[54:55]
    v_pk_mul_f32 v[40:41], v[40:41], v[56:57]
    v_pk_mul_f32 v[42:43], v[42:43], v[58:59]
    v_pk_mul_f32 v[44:45], v[44:45], v[60:61]
    v_pk_mul_f32 v[46:47], v[46:47], v[62:63]
    v_cvt_pk_bf16_f32 v64, v47, v46
    v_cvt_pk_bf16_f32 v65, v45, v44
    v_cvt_pk_bf16_f32 v66, v43, v42
    v_cvt_pk_bf16_f32 v67, v41, v40
    v_cvt_pk_bf16_f32 v68, v39, v38
    v_cvt_pk_bf16_f32 v69, v37, v36
    v_cvt_pk_bf16_f32 v70, v35, v34
    v_cvt_pk_bf16_f32 v71, v33, v32
    ds_write_b128 v105, v[64:67] offset:0
    ds_write_b128 v105, v[68:71] offset:16
    s_waitcnt lgkmcnt(0)
    s_nop 0
    ds_read_b128 v[168:171], v106 offset:0
    ds_read_b128 v[172:175], v106 offset:1152
    ds_read_b128 v[176:179], v106 offset:2304
    ds_read_b128 v[180:183], v106 offset:3456
    ds_read_b128 v[184:187], v106 offset:4608
    ds_read_b128 v[188:191], v106 offset:5760
    ds_read_b128 v[192:195], v106 offset:6912
    ds_read_b128 v[196:199], v106 offset:8064
    v_dot2_f32_bf16 v33, v130, v108, 0
    s_add_u32 m0, s80, 15360
    s_add_u32 s76, s83, 114688
    buffer_load_dwordx4 v84, s[40:43], s76 offen  lds
    v_dot2_f32_bf16 v32, v130, v110, 0
    v_dot2_f32_bf16 v35, v131, v108, 0
    v_dot2_f32_bf16 v34, v131, v110, 0
    v_dot2_f32_bf16 v37, v132, v108, 0
    v_dot2_f32_bf16 v36, v132, v110, 0
    v_dot2_f32_bf16 v39, v133, v108, 0
    v_dot2_f32_bf16 v38, v133, v110, 0
    s_add_u32 m0, s80, 16384
    s_add_u32 s76, s83, 122880
    buffer_load_dwordx4 v84, s[40:43], s76 offen  lds
    v_dot2_f32_bf16 v41, v134, v108, 0
    v_dot2_f32_bf16 v40, v134, v110, 0
    v_dot2_f32_bf16 v43, v135, v108, 0
    v_dot2_f32_bf16 v42, v135, v110, 0
    v_dot2_f32_bf16 v45, v136, v108, 0
    v_dot2_f32_bf16 v44, v136, v110, 0
    v_dot2_f32_bf16 v47, v137, v108, 0
    s_add_u32 m0, s80, 23552
    s_add_u32 s76, s83, 114688
    buffer_load_dwordx4 v84, s[44:47], s76 offen  lds
    v_dot2_f32_bf16 v46, v137, v110, 0
    v_dot2_f32_bf16 v33, v129, v109, v33
    v_dot2_f32_bf16 v32, v129, v111, v32
    v_dot2_f32_bf16 v35, v130, v109, v35
    v_dot2_f32_bf16 v34, v130, v111, v34
    v_dot2_f32_bf16 v37, v131, v109, v37
    v_dot2_f32_bf16 v36, v131, v111, v36
    s_add_u32 m0, s80, 24576
    s_add_u32 s76, s83, 122880
    buffer_load_dwordx4 v84, s[44:47], s76 offen  lds
    v_dot2_f32_bf16 v39, v132, v109, v39
    v_dot2_f32_bf16 v38, v132, v111, v38
    v_dot2_f32_bf16 v41, v133, v109, v41
    v_dot2_f32_bf16 v40, v133, v111, v40
    v_dot2_f32_bf16 v43, v134, v109, v43
    v_dot2_f32_bf16 v42, v134, v111, v42
    v_dot2_f32_bf16 v45, v135, v109, v45
    v_dot2_f32_bf16 v44, v135, v111, v44
    v_dot2_f32_bf16 v47, v136, v109, v47
    s_waitcnt vmcnt(8)
    s_nop 0
    ds_read_b64_tr_b16 v[148:149], v104 offset:10752
    ds_read_b64_tr_b16 v[150:151], v104 offset:11264
    ds_read_b64_tr_b16 v[152:153], v104 offset:11776
    ds_read_b64_tr_b16 v[154:155], v104 offset:12288
    ds_read_b64_tr_b16 v[156:157], v104 offset:12800
    ds_read_b64_tr_b16 v[158:159], v104 offset:19456
    ds_read_b64_tr_b16 v[160:161], v104 offset:19968
    ds_read_b64_tr_b16 v[162:163], v104 offset:20480
    ds_read_b64_tr_b16 v[164:165], v104 offset:20992
    v_dot2_f32_bf16 v46, v136, v111, v46
    v_dot2_f32_bf16 v32, v128, v112, v32
    v_dot2_f32_bf16 v34, v129, v112, v34
    v_dot2_f32_bf16 v36, v130, v112, v36
    v_dot2_f32_bf16 v38, v131, v112, v38
    v_dot2_f32_bf16 v40, v132, v112, v40
    v_dot2_f32_bf16 v42, v133, v112, v42
    v_dot2_f32_bf16 v44, v134, v112, v44
    v_dot2_f32_bf16 v46, v135, v112, v46
    v_lshlrev_b32 v48, 16, v138
    s_add_u32 s7, s69, 0
    s_waitcnt lgkmcnt(15)
    buffer_store_dwordx4 v[168:171], v107, s[64:67], s7 offen sc1
    v_and_b32 v49, 0xffff0000, v138
    v_lshlrev_b32 v50, 16, v139
    v_and_b32 v51, 0xffff0000, v139
    v_lshlrev_b32_e64 v52, 16, v140
    v_and_b32 v53, 0xffff0000, v140
    v_lshlrev_b32_e64 v54, 16, v141
    v_and_b32 v55, 0xffff0000, v141
    s_add_u32 s7, s69, 33792
    buffer_store_dwordx4 v[172:175], v107, s[64:67], s7 offen sc1
    v_lshlrev_b32_e64 v56, 16, v142
    v_and_b32 v57, 0xffff0000, v142
    v_lshlrev_b32_e64 v58, 16, v143
    v_and_b32 v59, 0xffff0000, v143
    v_lshlrev_b32_e64 v60, 16, v144
    v_and_b32 v61, 0xffff0000, v144
    v_lshlrev_b32_e64 v62, 16, v145
    v_and_b32 v63, 0xffff0000, v145
    s_add_u32 s7, s69, 67584
    s_waitcnt lgkmcnt(14)
    s_nop 0
    buffer_store_dwordx4 v[176:179], v107, s[64:67], s7 offen sc1
    v_pk_mul_f32 v[32:33], v[32:33], v[48:49]
    v_pk_mul_f32 v[34:35], v[34:35], v[50:51]
    v_pk_mul_f32 v[36:37], v[36:37], v[52:53]
    v_pk_mul_f32 v[38:39], v[38:39], v[54:55]
    v_pk_mul_f32 v[40:41], v[40:41], v[56:57]
    v_pk_mul_f32 v[42:43], v[42:43], v[58:59]
    v_pk_mul_f32 v[44:45], v[44:45], v[60:61]
    v_pk_mul_f32 v[46:47], v[46:47], v[62:63]
    s_add_u32 s7, s69, 101376
    s_waitcnt lgkmcnt(13)
    s_nop 0
    buffer_store_dwordx4 v[180:183], v107, s[64:67], s7 offen sc1
    v_cvt_pk_bf16_f32 v64, v47, v46
    v_cvt_pk_bf16_f32 v65, v45, v44
    v_cvt_pk_bf16_f32 v66, v43, v42
    v_cvt_pk_bf16_f32 v67, v41, v40
    v_cvt_pk_bf16_f32 v68, v39, v38
    v_cvt_pk_bf16_f32 v69, v37, v36
    v_cvt_pk_bf16_f32 v70, v35, v34
    v_cvt_pk_bf16_f32 v71, v33, v32
    ds_write_b128 v105, v[64:67] offset:96
    ds_write_b128 v105, v[68:71] offset:112
    s_waitcnt lgkmcnt(9)
    s_nop 0
    v_dot2_f32_bf16 v33, v150, v108, 0
    s_add_u32 s7, s69, 135168
    buffer_store_dwordx4 v[184:187], v107, s[64:67], s7 offen sc1
    v_dot2_f32_bf16 v32, v150, v110, 0
    v_dot2_f32_bf16 v35, v151, v108, 0
    v_dot2_f32_bf16 v34, v151, v110, 0
    s_waitcnt lgkmcnt(8)
    s_nop 0
    v_dot2_f32_bf16 v37, v152, v108, 0
    v_dot2_f32_bf16 v36, v152, v110, 0
    v_dot2_f32_bf16 v39, v153, v108, 0
    v_dot2_f32_bf16 v38, v153, v110, 0
    s_waitcnt lgkmcnt(7)
    s_nop 0
    v_dot2_f32_bf16 v41, v154, v108, 0
    v_dot2_f32_bf16 v40, v154, v110, 0
    v_dot2_f32_bf16 v43, v155, v108, 0
    v_dot2_f32_bf16 v42, v155, v110, 0
    s_waitcnt lgkmcnt(6)
    s_nop 0
    v_dot2_f32_bf16 v45, v156, v108, 0
    v_dot2_f32_bf16 v44, v156, v110, 0
    v_dot2_f32_bf16 v47, v157, v108, 0
    v_dot2_f32_bf16 v46, v157, v110, 0
    v_dot2_f32_bf16 v33, v149, v109, v33
    v_dot2_f32_bf16 v32, v149, v111, v32
    s_add_u32 s7, s69, 168960
    buffer_store_dwordx4 v[188:191], v107, s[64:67], s7 offen sc1
    v_dot2_f32_bf16 v35, v150, v109, v35
    v_dot2_f32_bf16 v34, v150, v111, v34
    v_dot2_f32_bf16 v37, v151, v109, v37
    v_dot2_f32_bf16 v36, v151, v111, v36
    v_dot2_f32_bf16 v39, v152, v109, v39
    v_dot2_f32_bf16 v38, v152, v111, v38
    v_dot2_f32_bf16 v41, v153, v109, v41
    v_dot2_f32_bf16 v40, v153, v111, v40
    v_dot2_f32_bf16 v43, v154, v109, v43
    v_dot2_f32_bf16 v42, v154, v111, v42
    v_dot2_f32_bf16 v45, v155, v109, v45
    v_dot2_f32_bf16 v44, v155, v111, v44
    v_dot2_f32_bf16 v47, v156, v109, v47
    s_waitcnt vmcnt(10)
    s_nop 0
    ds_read_b64_tr_b16 v[128:129], v104 offset:12800
    ds_read_b64_tr_b16 v[130:131], v104 offset:13312
    ds_read_b64_tr_b16 v[132:133], v104 offset:13824
    ds_read_b64_tr_b16 v[134:135], v104 offset:14336
    ds_read_b64_tr_b16 v[136:137], v104 offset:14848
    ds_read_b64_tr_b16 v[138:139], v104 offset:21504
    ds_read_b64_tr_b16 v[140:141], v104 offset:22016
    ds_read_b64_tr_b16 v[142:143], v104 offset:22528
    ds_read_b64_tr_b16 v[144:145], v104 offset:23040
    v_dot2_f32_bf16 v46, v156, v111, v46
    v_dot2_f32_bf16 v32, v148, v112, v32
    v_dot2_f32_bf16 v34, v149, v112, v34
    v_dot2_f32_bf16 v36, v150, v112, v36
    v_dot2_f32_bf16 v38, v151, v112, v38
    s_add_u32 s7, s69, 202752
    buffer_store_dwordx4 v[192:195], v107, s[64:67], s7 offen sc1
    v_dot2_f32_bf16 v40, v152, v112, v40
    v_dot2_f32_bf16 v42, v153, v112, v42
    v_dot2_f32_bf16 v44, v154, v112, v44
    v_dot2_f32_bf16 v46, v155, v112, v46
    s_waitcnt lgkmcnt(14)
    v_lshlrev_b32 v48, 16, v158
    v_and_b32 v49, 0xffff0000, v158
    v_lshlrev_b32_e64 v50, 16, v159
    v_and_b32 v51, 0xffff0000, v159
    s_waitcnt lgkmcnt(13)
    v_lshlrev_b32 v52, 16, v160
    v_and_b32 v53, 0xffff0000, v160
    v_lshlrev_b32_e64 v54, 16, v161
    v_and_b32 v55, 0xffff0000, v161
    s_waitcnt lgkmcnt(12)
    v_lshlrev_b32 v56, 16, v162
    v_and_b32 v57, 0xffff0000, v162
    v_lshlrev_b32_e64 v58, 16, v163
    v_and_b32 v59, 0xffff0000, v163
    s_waitcnt lgkmcnt(11)
    v_lshlrev_b32 v60, 16, v164
    v_and_b32 v61, 0xffff0000, v164
    s_add_u32 s7, s69, 236544
    buffer_store_dwordx4 v[196:199], v107, s[64:67], s7 offen sc1
    v_lshlrev_b32_e64 v62, 16, v165
    v_and_b32 v63, 0xffff0000, v165
    v_pk_mul_f32 v[32:33], v[32:33], v[48:49]
    v_pk_mul_f32 v[34:35], v[34:35], v[50:51]
    v_pk_mul_f32 v[36:37], v[36:37], v[52:53]
    v_pk_mul_f32 v[38:39], v[38:39], v[54:55]
    v_pk_mul_f32 v[40:41], v[40:41], v[56:57]
    v_pk_mul_f32 v[42:43], v[42:43], v[58:59]
    v_pk_mul_f32 v[44:45], v[44:45], v[60:61]
    v_pk_mul_f32 v[46:47], v[46:47], v[62:63]
    v_cvt_pk_bf16_f32 v64, v47, v46
    v_cvt_pk_bf16_f32 v65, v45, v44
    v_cvt_pk_bf16_f32 v66, v43, v42
    v_cvt_pk_bf16_f32 v67, v41, v40
    v_cvt_pk_bf16_f32 v68, v39, v38
    v_cvt_pk_bf16_f32 v69, v37, v36
    v_cvt_pk_bf16_f32 v70, v35, v34
    v_cvt_pk_bf16_f32 v71, v33, v32
    ds_write_b128 v105, v[64:67] offset:64
    ds_write_b128 v105, v[68:71] offset:80
    s_waitcnt lgkmcnt(9)
    s_nop 0
    v_dot2_f32_bf16 v33, v130, v108, 0
    v_dot2_f32_bf16 v32, v130, v110, 0
    v_dot2_f32_bf16 v35, v131, v108, 0
    v_dot2_f32_bf16 v34, v131, v110, 0
    s_waitcnt lgkmcnt(8)
    s_nop 0
    v_dot2_f32_bf16 v37, v132, v108, 0
    v_dot2_f32_bf16 v36, v132, v110, 0
    v_dot2_f32_bf16 v39, v133, v108, 0
    v_dot2_f32_bf16 v38, v133, v110, 0
    s_waitcnt lgkmcnt(7)
    s_nop 0
    v_dot2_f32_bf16 v41, v134, v108, 0
    v_dot2_f32_bf16 v40, v134, v110, 0
    v_dot2_f32_bf16 v43, v135, v108, 0
    v_dot2_f32_bf16 v42, v135, v110, 0
    s_waitcnt lgkmcnt(6)
    s_nop 0
    v_dot2_f32_bf16 v45, v136, v108, 0
    v_dot2_f32_bf16 v44, v136, v110, 0
    v_dot2_f32_bf16 v47, v137, v108, 0
    v_dot2_f32_bf16 v46, v137, v110, 0
    v_dot2_f32_bf16 v33, v129, v109, v33
    v_dot2_f32_bf16 v32, v129, v111, v32
    v_dot2_f32_bf16 v35, v130, v109, v35
    v_dot2_f32_bf16 v34, v130, v111, v34
    v_dot2_f32_bf16 v37, v131, v109, v37
    v_dot2_f32_bf16 v36, v131, v111, v36
    v_dot2_f32_bf16 v39, v132, v109, v39
    v_dot2_f32_bf16 v38, v132, v111, v38
    v_dot2_f32_bf16 v41, v133, v109, v41
    v_dot2_f32_bf16 v40, v133, v111, v40
    v_dot2_f32_bf16 v43, v134, v109, v43
    v_dot2_f32_bf16 v42, v134, v111, v42
    v_dot2_f32_bf16 v45, v135, v109, v45
    v_dot2_f32_bf16 v44, v135, v111, v44
    v_dot2_f32_bf16 v47, v136, v109, v47
    s_waitcnt vmcnt(8)
    s_nop 0
    ds_read_b64_tr_b16 v[148:149], v104 offset:14848
    ds_read_b64_tr_b16 v[150:151], v104 offset:15360
    ds_read_b64_tr_b16 v[152:153], v104 offset:15872
    ds_read_b64_tr_b16 v[154:155], v104 offset:16384
    ds_read_b64_tr_b16 v[156:157], v104 offset:16896
    ds_read_b64_tr_b16 v[158:159], v104 offset:23552
    ds_read_b64_tr_b16 v[160:161], v104 offset:24064
    ds_read_b64_tr_b16 v[162:163], v104 offset:24576
    ds_read_b64_tr_b16 v[164:165], v104 offset:25088
    v_dot2_f32_bf16 v46, v136, v111, v46
    v_dot2_f32_bf16 v32, v128, v112, v32
    v_dot2_f32_bf16 v34, v129, v112, v34
    v_dot2_f32_bf16 v36, v130, v112, v36
    v_dot2_f32_bf16 v38, v131, v112, v38
    v_dot2_f32_bf16 v40, v132, v112, v40
    v_dot2_f32_bf16 v42, v133, v112, v42
    v_dot2_f32_bf16 v44, v134, v112, v44
    v_dot2_f32_bf16 v46, v135, v112, v46
    s_waitcnt lgkmcnt(14)
    v_lshlrev_b32 v48, 16, v138
    v_and_b32 v49, 0xffff0000, v138
    v_lshlrev_b32_e64 v50, 16, v139
    v_and_b32 v51, 0xffff0000, v139
    s_waitcnt lgkmcnt(13)
    v_lshlrev_b32 v52, 16, v140
    v_and_b32 v53, 0xffff0000, v140
    v_lshlrev_b32_e64 v54, 16, v141
    v_and_b32 v55, 0xffff0000, v141
    s_waitcnt lgkmcnt(12)
    v_lshlrev_b32 v56, 16, v142
    v_and_b32 v57, 0xffff0000, v142
    v_lshlrev_b32_e64 v58, 16, v143
    v_and_b32 v59, 0xffff0000, v143
    s_waitcnt lgkmcnt(11)
    v_lshlrev_b32 v60, 16, v144
    v_and_b32 v61, 0xffff0000, v144
    v_lshlrev_b32_e64 v62, 16, v145
    v_and_b32 v63, 0xffff0000, v145
    v_pk_mul_f32 v[32:33], v[32:33], v[48:49]
    v_pk_mul_f32 v[34:35], v[34:35], v[50:51]
    v_pk_mul_f32 v[36:37], v[36:37], v[52:53]
    v_pk_mul_f32 v[38:39], v[38:39], v[54:55]
    v_pk_mul_f32 v[40:41], v[40:41], v[56:57]
    v_pk_mul_f32 v[42:43], v[42:43], v[58:59]
    v_pk_mul_f32 v[44:45], v[44:45], v[60:61]
    v_pk_mul_f32 v[46:47], v[46:47], v[62:63]
    v_cvt_pk_bf16_f32 v64, v47, v46
    v_cvt_pk_bf16_f32 v65, v45, v44
    v_cvt_pk_bf16_f32 v66, v43, v42
    v_cvt_pk_bf16_f32 v67, v41, v40
    v_cvt_pk_bf16_f32 v68, v39, v38
    v_cvt_pk_bf16_f32 v69, v37, v36
    v_cvt_pk_bf16_f32 v70, v35, v34
    v_cvt_pk_bf16_f32 v71, v33, v32
    ds_write_b128 v105, v[64:67] offset:32
    ds_write_b128 v105, v[68:71] offset:48
    s_waitcnt lgkmcnt(9)
    s_nop 0
    v_dot2_f32_bf16 v33, v150, v108, 0
    v_dot2_f32_bf16 v32, v150, v110, 0
    v_dot2_f32_bf16 v35, v151, v108, 0
    v_dot2_f32_bf16 v34, v151, v110, 0
    s_waitcnt lgkmcnt(8)
    s_nop 0
    v_dot2_f32_bf16 v37, v152, v108, 0
    v_dot2_f32_bf16 v36, v152, v110, 0
    v_dot2_f32_bf16 v39, v153, v108, 0
    v_dot2_f32_bf16 v38, v153, v110, 0
    s_waitcnt lgkmcnt(7)
    s_nop 0
    v_dot2_f32_bf16 v41, v154, v108, 0
    v_dot2_f32_bf16 v40, v154, v110, 0
    v_dot2_f32_bf16 v43, v155, v108, 0
    v_dot2_f32_bf16 v42, v155, v110, 0
    s_waitcnt lgkmcnt(6)
    s_nop 0
    v_dot2_f32_bf16 v45, v156, v108, 0
    v_dot2_f32_bf16 v44, v156, v110, 0
    v_dot2_f32_bf16 v47, v157, v108, 0
    v_dot2_f32_bf16 v46, v157, v110, 0
    v_dot2_f32_bf16 v33, v149, v109, v33
    v_dot2_f32_bf16 v32, v149, v111, v32
    v_dot2_f32_bf16 v35, v150, v109, v35
    v_dot2_f32_bf16 v34, v150, v111, v34
    v_dot2_f32_bf16 v37, v151, v109, v37
    v_dot2_f32_bf16 v36, v151, v111, v36
    v_dot2_f32_bf16 v39, v152, v109, v39
    v_dot2_f32_bf16 v38, v152, v111, v38
    v_dot2_f32_bf16 v41, v153, v109, v41
    v_dot2_f32_bf16 v40, v153, v111, v40
    v_dot2_f32_bf16 v43, v154, v109, v43
    v_dot2_f32_bf16 v42, v154, v111, v42
    v_dot2_f32_bf16 v45, v155, v109, v45
    v_dot2_f32_bf16 v44, v155, v111, v44
    v_dot2_f32_bf16 v47, v156, v109, v47
    v_dot2_f32_bf16 v46, v156, v111, v46
    v_dot2_f32_bf16 v32, v148, v112, v32
    v_dot2_f32_bf16 v34, v149, v112, v34
    v_dot2_f32_bf16 v36, v150, v112, v36
    v_dot2_f32_bf16 v38, v151, v112, v38
    v_dot2_f32_bf16 v40, v152, v112, v40
    v_dot2_f32_bf16 v42, v153, v112, v42
    v_dot2_f32_bf16 v44, v154, v112, v44
    v_dot2_f32_bf16 v46, v155, v112, v46
    s_waitcnt lgkmcnt(5)
    v_lshlrev_b32 v48, 16, v158
    v_and_b32 v49, 0xffff0000, v158
    v_lshlrev_b32_e64 v50, 16, v159
    v_and_b32 v51, 0xffff0000, v159
    s_waitcnt lgkmcnt(4)
    v_lshlrev_b32 v52, 16, v160
    v_and_b32 v53, 0xffff0000, v160
    v_lshlrev_b32_e64 v54, 16, v161
    v_and_b32 v55, 0xffff0000, v161
    s_waitcnt lgkmcnt(3)
    v_lshlrev_b32 v56, 16, v162
    v_and_b32 v57, 0xffff0000, v162
    v_lshlrev_b32_e64 v58, 16, v163
    v_and_b32 v59, 0xffff0000, v163
    s_waitcnt lgkmcnt(2)
    v_lshlrev_b32 v60, 16, v164
    v_and_b32 v61, 0xffff0000, v164
    v_lshlrev_b32_e64 v62, 16, v165
    v_and_b32 v63, 0xffff0000, v165
    v_pk_mul_f32 v[32:33], v[32:33], v[48:49]
    v_pk_mul_f32 v[34:35], v[34:35], v[50:51]
    v_pk_mul_f32 v[36:37], v[36:37], v[52:53]
    v_pk_mul_f32 v[38:39], v[38:39], v[54:55]
    v_pk_mul_f32 v[40:41], v[40:41], v[56:57]
    v_pk_mul_f32 v[42:43], v[42:43], v[58:59]
    v_pk_mul_f32 v[44:45], v[44:45], v[60:61]
    v_pk_mul_f32 v[46:47], v[46:47], v[62:63]
    v_cvt_pk_bf16_f32 v64, v47, v46
    v_cvt_pk_bf16_f32 v65, v45, v44
    v_cvt_pk_bf16_f32 v66, v43, v42
    v_cvt_pk_bf16_f32 v67, v41, v40
    v_cvt_pk_bf16_f32 v68, v39, v38
    v_cvt_pk_bf16_f32 v69, v37, v36
    v_cvt_pk_bf16_f32 v70, v35, v34
    v_cvt_pk_bf16_f32 v71, v33, v32
    ds_write_b128 v105, v[64:67] offset:0
    ds_write_b128 v105, v[68:71] offset:16
    s_waitcnt lgkmcnt(0)
    s_nop 0
    ds_read_b128 v[168:171], v106 offset:0
    ds_read_b128 v[172:175], v106 offset:1152
    ds_read_b128 v[176:179], v106 offset:2304
    ds_read_b128 v[180:183], v106 offset:3456
    ds_read_b128 v[184:187], v106 offset:4608
    ds_read_b128 v[188:191], v106 offset:5760
    ds_read_b128 v[192:195], v106 offset:6912
    ds_read_b128 v[196:199], v106 offset:8064
    s_add_u32 s7, s69, -128
    s_waitcnt lgkmcnt(7)
    buffer_store_dwordx4 v[168:171], v107, s[64:67], s7 offen sc1
    s_add_u32 s7, s69, 33664
    s_waitcnt lgkmcnt(6)
    buffer_store_dwordx4 v[172:175], v107, s[64:67], s7 offen sc1
    s_add_u32 s7, s69, 67456
    s_waitcnt lgkmcnt(5)
    buffer_store_dwordx4 v[176:179], v107, s[64:67], s7 offen sc1
    s_add_u32 s7, s69, 101248
    s_waitcnt lgkmcnt(4)
    buffer_store_dwordx4 v[180:183], v107, s[64:67], s7 offen sc1
    s_add_u32 s7, s69, 135040
    s_waitcnt lgkmcnt(3)
    buffer_store_dwordx4 v[184:187], v107, s[64:67], s7 offen sc1
    s_add_u32 s7, s69, 168832
    s_waitcnt lgkmcnt(2)
    buffer_store_dwordx4 v[188:191], v107, s[64:67], s7 offen sc1
    s_add_u32 s7, s69, 202624
    s_waitcnt lgkmcnt(1)
    buffer_store_dwordx4 v[192:195], v107, s[64:67], s7 offen sc1
    s_add_u32 s7, s69, 236416
    s_waitcnt lgkmcnt(0)
    buffer_store_dwordx4 v[196:199], v107, s[64:67], s7 offen sc1
    s_and_b32 s75, s3, 1
    s_lshl_b32 s74, s75, 11
    s_add_u32 s74, s74, s10
    v_add_u32 v92, s74, v122
    v_mul_u32_u24 v93, 4160, v3
    v_lshl_add_u32 v93, v4, 1, v93
    v_add_u32 v93, s10, v93
    v_add_u32 v94, s10, v122
    v_add_u32 v123, v4, v3
    v_subrev_u32 v123, 16, v123
    v_lshlrev_b32_e64 v124, 4, v123
    v_lshrrev_b64 v[66:67], v124, s[100:101]
    v_cmp_gt_i32 vcc, 0, v123
    s_nop 1
    v_cndmask_b32 v66, v66, 0, vcc
    v_add_u32 v123, 1, v4
    v_and_b32 v124, 3, v123
    v_mul_u32_u24 v124, 4160, v124
    v_and_b32_e64 v123, 28, v123
    v_lshl_add_u32 v124, v123, 1, v124
    v_lshl_add_u32 v124, v3, 4, v124
    s_lshl_b32 s74, s75, 8
    s_add_u32 s74, s74, s10
    v_add_u32 v70, s74, v124
    v_lshlrev_b32 v124, 5, v4
    v_lshlrev_b32 v125, 4, v3
    v_sub_u32 v125, v125, v124
    s_add_u32 s74, s74, 17120
    v_add_u32 v71, s74, v125
    v_lshlrev_b32 v125, 3, v3
    v_add_u32 v125, v125, v124
    s_lshl_b32 s74, s75, 11
    s_sub_u32 s74, s10, s74
    s_add_u32 s74, s74, 19192
    v_sub_u32 v69, s74, v125
    v_and_b32_e64 v125, 1, v3
    v_lshl_add_u32 v124, v125, 9, v124
    v_lshrrev_b32_e64 v125, 1, v3
    v_lshl_add_u32 v68, v125, 4, v124
    s_mov_b32 s86, 0
    s_nop 0
    s_mov_b32 s87, 4096
    s_mov_b32 s88, 8192
    s_mov_b32 s89, 12288
    s_mov_b32 s90, 16384
    s_mov_b32 s91, 20480
    s_mov_b32 s92, 24576
    s_mul_i32 s11, s71, 229376
    s_mul_i32 s74, s3, 28672
    s_add_u32 s11, s11, s74
    s_add_u32 s11, s11, 6291456
    v_lshrrev_b32 v124, 1, v3
    v_lshlrev_b32 v124, 10, v124
    v_and_b32 v125, 1, v3
    v_lshl_add_u32 v124, v125, 9, v124
    v_lshl_add_u32 v124, v4, 4, v124
    v_add_u32_e64 v9, s11, v124
    v_add_u32 v18, 114688, v9
    s_mul_i32 s93, s72, 229376
    s_mul_i32 s74, s3, 57344
    s_add_u32 s93, s93, s74
    s_add_u32 s93, s93, 14155776
    s_lshl_b32 s7, s71, 16
    s_lshl_b32 s74, s72, 7
    s_add_u32 s7, s7, s74
    s_lshl_b32 s74, s3, 14
    s_add_u32 s46, s7, s74
    s_lshl_b32 s74, s3, 5
    s_add_u32 s7, s7, s74
    v_lshlrev_b32_e64 v124, 10, v4
    v_lshl_add_u32 v124, v3, 3, v124
    v_add_u32 v64, s7, v124
    s_lshl_b32 s7, s71, 9
    s_add_u32 s7, s7, 262144
    v_lshl_add_u32 v65, v4, 3, s7
    v_xor_b32 v124, v6, v5
    v_lshlrev_b32 v124, 4, v124
    v_lshl_add_u32 v67, v5, 10, v124
    v_add_u32 v76, 7168, v67
    v_lshrrev_b32_e64 v124, 1, v3
    v_lshl_add_u32 v124, s3, 1, v124
    v_xor_b32 v124, v124, v6
    v_lshlrev_b32 v124, 4, v124
    v_lshl_add_u32 v124, v4, 7, v124
    v_lshl_add_u32 v124, v125, 3, v124
    v_add_u32 v77, 65536, v124
    s_lshl_b32 s7, s72, 6
    s_lshl_b32 s74, s3, 4
    s_add_u32 s7, s7, s74
    s_mul_i32 s7, s7, 4224
    s_lshl_b32 s74, s71, 7
    s_add_u32 s7, s7, s74
    s_nop 0
    s_add_u32 s16, s7, 3276800
    s_add_u32 s17, s16, 33792
    v_mul_u32_u24 v124, 4224, v5
    v_lshl_add_u32 v78, v6, 4, v124
    s_mul_i32 s7, s3, 2560
    s_add_u32 s7, s7, 32768
    v_mul_u32_u24 v124, 160, v5
    v_lshl_add_u32 v124, v6, 4, v124
    v_add_u32_e64 v79, s7, v124
    v_lshl_add_u32 v124, v3, 2, v7
    v_mul_u32_u24 v124, 160, v124
    v_lshl_add_u32 v124, v8, 3, v124
    v_add_u32 v80, s7, v124
    s_lshl_b32 s7, s72, 12
    s_add_u32 s7, s7, 65536
    s_or_b32 s7, s7, s20
    v_and_b32 v124, 31, v1
    v_lshl_add_u32 v81, v124, 7, s7
    s_lshl_b32 s7, s71, 13
    s_add_u32 s7, s7, 786432
    s_or_b32 s7, s7, s20
    v_min_u32_e64 v124, 27, v1
    v_lshl_add_u32 v82, v124, 7, s7
    s_lshr_b32 s7, s4, 2
    s_lshl_b32 s7, s7, 7
    s_add_u32 s7, s7, 8192
    s_or_b32 s7, s7, s20
    v_lshl_add_u32 v83, v4, 8, s7
    s_lshl_b32 s7, s3, 12
    s_add_u32 s74, s7, 49152
    v_add_u32_e64 v95, s74, v122
    v_xor_b32 v120, 4096, v95
    s_add_u32 s74, s7, 0
    v_add_u32 v123, s74, v122
    s_lshl_b32 s7, s3, 10
    s_add_u32 s74, s7, 0
    v_add_u32 v121, s74, v122
    s_lshl_b32 s14, s3, 11
    s_add_u32 s14, s14, 65536
    s_lshl_b32 s7, s85, 16
    s_and_b32 s74, s85, 0xffff0000
    s_bitcmp1_b32 s73, 0
    s_cselect_b32 s45, s74, s7
    s_lshl_b32 s43, s4, 12
    s_lshl_b32 s74, s5, 7
    s_add_u32 s43, s43, s74
    s_add_u32 s43, s43, 65536
    s_waitcnt vmcnt(0)
    s_barrier
    s_lshl_b32 s7, s97, 7
    s_add_u32 s7, s7, 8192
    s_or_b32 s78, s7, s20
    v_mov_b32 v10, s78
    v_mov_b32 v11, s6
    s_mov_b64 exec, 1
    buffer_store_dword v11, v10, s[64:67], 0 offen sc1
    s_mov_b64 exec, -1
    buffer_load_dwordx4 v[32:35], v122, s[52:55], s31 offen offset:0
    buffer_load_dwordx4 v[36:39], v122, s[52:55], s31 offen offset:8
    buffer_load_dwordx4 v[40:43], v122, s[52:55], s31 offen offset:1024
    buffer_load_dwordx4 v[44:47], v122, s[52:55], s31 offen offset:1032
    v_min_u32_e64 v23, 6, v6
    v_lshl_add_u32 v23, v5, 3, v23
    s_lshr_b32 s7, s72, 1
    s_lshl_b32 s7, s7, 7
    s_add_u32 s7, s7, 32768
    v_lshl_add_u32 v22, v23, 9, s7
    v_or_b32_e64 v22, s20, v22
    buffer_load_dword v23, v22, s[64:67], 0 offen sc1
    buffer_load_dword v127, v83, s[64:67], 0 offen sc1
    s_waitcnt vmcnt(5)
    v_alignbit_b32 v48, v33, v32, 16
    v_alignbit_b32 v49, v34, v33, 16
    v_alignbit_b32 v50, v35, v34, 16
    s_waitcnt vmcnt(4)
    v_alignbit_b32 v51, v38, v35, 16
    v_alignbit_b32 v52, v34, v33, 16
    v_alignbit_b32 v53, v35, v34, 16
    v_alignbit_b32 v54, v38, v35, 16
    v_alignbit_b32 v55, v39, v38, 16
    v_mov_b32 v39, v38
    v_mov_b32 v38, v35
    v_mov_b32 v37, v34
    v_mov_b32 v36, v33
    s_waitcnt vmcnt(3)
    v_alignbit_b32 v56, v41, v40, 16
    v_alignbit_b32 v57, v42, v41, 16
    v_alignbit_b32 v58, v43, v42, 16
    s_waitcnt vmcnt(2)
    v_alignbit_b32 v59, v46, v43, 16
    v_alignbit_b32 v60, v42, v41, 16
    v_alignbit_b32 v61, v43, v42, 16
    v_alignbit_b32 v62, v46, v43, 16
    v_alignbit_b32 v63, v47, v46, 16
    v_mov_b32 v47, v46
    v_mov_b32 v46, v43
    v_mov_b32 v45, v42
    v_mov_b32 v44, v41
    v_mov_b32 v12, 0
    v_mov_b32 v13, 0
    v_mov_b32 v14, 0
    v_mov_b32 v15, 0
    ds_write_b128 v94, v[12:15] offset:20736
    ds_write_b16 v93, v66
    ds_write_b128 v92, v[32:35] offset:32
    ds_write_b128 v92, v[36:39] offset:8352
    ds_write_b128 v92, v[48:51] offset:4192
    ds_write_b128 v92, v[52:55] offset:12512
    ds_write_b128 v92, v[40:43] offset:1056
    ds_write_b128 v92, v[44:47] offset:9376
    ds_write_b128 v92, v[56:59] offset:5216
    ds_write_b128 v92, v[60:63] offset:13536
    s_waitcnt vmcnt(1)
    v_cmp_ne_u32 vcc, s21, v23
    s_nop 0
    s_cbranch_vccnz L_wfs_slow
L_wfs_ok:
    s_waitcnt vmcnt(0)
    v_cmp_ne_u32 vcc, s21, v127
    s_nop 0
    s_cbranch_vccnz L_pfs_slow
L_pfs_ok:
    s_barrier
    s_nop 0
    s_add_u32 s77, s96, 1048576
    buffer_load_dwordx4 a[192:195], v122, s[64:67], s77 offen sc1
    buffer_load_dwordx4 a[196:199], v122, s[64:67], s77 offen offset:1024 sc1
    s_add_u32 s31, s96, 3276800
    buffer_load_dwordx4 a[0:3], v122, s[64:67], s93 offen offset:0 sc1
    buffer_load_dwordx4 a[4:7], v122, s[64:67], s93 offen offset:1024 sc1
    buffer_load_dwordx4 a[8:11], v122, s[64:67], s93 offen offset:2048 sc1
    buffer_load_dwordx4 a[12:15], v122, s[64:67], s93 offen offset:3072 sc1
    s_add_u32 s93, s93, 4096
    buffer_load_dwordx4 a[16:19], v122, s[64:67], s93 offen offset:0 sc1
    buffer_load_dwordx4 a[20:23], v122, s[64:67], s93 offen offset:1024 sc1
    buffer_load_dwordx4 a[24:27], v122, s[64:67], s93 offen offset:2048 sc1
    buffer_load_dwordx4 a[28:31], v122, s[64:67], s93 offen offset:3072 sc1
    s_add_u32 s93, s93, 4096
    buffer_load_dwordx4 a[32:35], v122, s[64:67], s93 offen offset:0 sc1
    buffer_load_dwordx4 a[36:39], v122, s[64:67], s93 offen offset:1024 sc1
    buffer_load_dwordx4 a[40:43], v122, s[64:67], s93 offen offset:2048 sc1
    buffer_load_dwordx4 a[44:47], v122, s[64:67], s93 offen offset:3072 sc1
    s_add_u32 s93, s93, 4096
    buffer_load_dwordx4 a[48:51], v122, s[64:67], s93 offen offset:0 sc1
    buffer_load_dwordx4 a[52:55], v122, s[64:67], s93 offen offset:1024 sc1
    buffer_load_dwordx4 a[56:59], v122, s[64:67], s93 offen offset:2048 sc1
    buffer_load_dwordx4 a[60:63], v122, s[64:67], s93 offen offset:3072 sc1
    s_add_u32 s93, s93, 4096
    buffer_load_dwordx4 a[64:67], v122, s[64:67], s93 offen offset:0 sc1
    buffer_load_dwordx4 a[68:71], v122, s[64:67], s93 offen offset:1024 sc1
    buffer_load_dwordx4 a[72:75], v122, s[64:67], s93 offen offset:2048 sc1
    buffer_load_dwordx4 a[76:79], v122, s[64:67], s93 offen offset:3072 sc1
    s_add_u32 s93, s93, 4096
    buffer_load_dwordx4 a[80:83], v122, s[64:67], s93 offen offset:0 sc1
    buffer_load_dwordx4 a[84:87], v122, s[64:67], s93 offen offset:1024 sc1
    buffer_load_dwordx4 a[88:91], v122, s[64:67], s93 offen offset:2048 sc1
    buffer_load_dwordx4 a[92:95], v122, s[64:67], s93 offen offset:3072 sc1
    s_add_u32 s93, s93, 4096
    buffer_load_dwordx4 a[96:99], v122, s[64:67], s93 offen offset:0 sc1
    buffer_load_dwordx4 a[100:103], v122, s[64:67], s93 offen offset:1024 sc1
    buffer_load_dwordx4 a[104:107], v122, s[64:67], s93 offen offset:2048 sc1
    buffer_load_dwordx4 a[108:111], v122, s[64:67], s93 offen offset:3072 sc1
    s_add_u32 s93, s93, 4096
    buffer_load_dwordx4 a[112:115], v122, s[64:67], s93 offen offset:0 sc1
    buffer_load_dwordx4 a[116:119], v122, s[64:67], s93 offen offset:1024 sc1
    s_waitcnt vmcnt(31)
    ds_write_b128 v92, a[192:195] offset:16640
    s_waitcnt vmcnt(30)
    ds_write_b128 v92, a[196:199] offset:17664
    s_cmp_lg_u32 s2, 224
    s_cbranch_scc1 L_noep
    s_cmp_lg_u32 s3, 0
    s_cbranch_scc1 L_noep
    v_lshlrev_b32 v126, 7, v1
    v_add_u32 v126, 32768, v126
    buffer_load_dword v127, v126, s[64:67], 0 offen sc1
    s_waitcnt vmcnt(0)
    v_cmp_ne_u32 vcc, s6, v127
    s_nop 0
    s_cbranch_vccnz L_ep0_slow
L_ep0_ok:
    v_add_u32 v126, 8192, v126
    buffer_load_dword v127, v126, s[64:67], 0 offen sc1
    s_waitcnt vmcnt(0)
    v_cmp_ne_u32 vcc, s6, v127
    s_nop 0
    s_cbranch_vccnz L_ep1_slow
L_ep1_ok:
    v_add_u32 v126, 8192, v126
    buffer_load_dword v127, v126, s[64:67], 0 offen sc1
    s_waitcnt vmcnt(0)
    v_cmp_ne_u32 vcc, s6, v127
    s_nop 0
    s_cbranch_vccnz L_ep2_slow
L_ep2_ok:
    v_add_u32 v126, 8192, v126
    buffer_load_dword v127, v126, s[64:67], 0 offen sc1
    s_waitcnt vmcnt(0)
    v_cmp_ne_u32 vcc, s6, v127
    s_nop 0
    s_cbranch_vccnz L_ep3_slow
L_ep3_ok:
    v_add_u32 v126, 8192, v126
    s_mov_b32 s7, 0
    v_mov_b32 v10, s7
    v_mov_b32 v11, s6
    s_mov_b64 exec, 1
    buffer_store_dword v11, v10, s[64:67], 0 offen sc1
    s_mov_b64 exec, -1
L_noep:
    s_mov_b32 s84, 0x80000000
    s_waitcnt vmcnt(0) lgkmcnt(0)
    s_barrier
    s_nop 0
    ds_read_b128 v[160:163], v71 offset:3584
    ds_read_b64 v[128:129], v70 offset:0
    ds_read_b64 v[130:131], v70 offset:8
    ds_read_b128 v[164:167], v71 offset:3072
    ds_read_b64 v[132:133], v70 offset:512
    ds_read_b64 v[134:135], v70 offset:520
    ds_read_b128 v[168:171], v71 offset:2560
    ds_read_b64 v[136:137], v70 offset:1024
    ds_read_b64 v[138:139], v70 offset:1032
    ds_read_b128 v[172:175], v71 offset:2048
    ds_read_b64 v[140:141], v70 offset:1536
    ds_read_b64 v[142:143], v70 offset:1544
    s_waitcnt vmcnt(0) lgkmcnt(0)
    s_branch L_tail
L_codeend:
.section .rodata,"a"
.p2align 6
.amdhsa_kernel recurrent_scan__ssm_conv_h3__swiglu_ffn__prompt_kernel
  .amdhsa_next_free_vgpr 512
  .amdhsa_next_free_sgpr 102
  .amdhsa_accum_offset 256
  .amdhsa_group_segment_fixed_size 0
  .amdhsa_kernarg_size 104
  .amdhsa_user_sgpr_count 2
  .amdhsa_user_sgpr_kernarg_segment_ptr 1
  .amdhsa_system_sgpr_workgroup_id_x 1
.end_amdhsa_kernel
```
